```python
import torch

def _softmax(x, axis=-1):
    return torch.softmax(x, dim=axis)
def _gelu(x):
    return torch.nn.functional.gelu(x, approximate="tanh")
def _silu(x):
    return torch.nn.functional.silu(x)
def _sigmoid(x):
    return torch.sigmoid(x)
def _layernorm(x, axis=-1, eps=1e-5):
    m = x.mean(dim=axis, keepdim=True)
    v = x.var(dim=axis, keepdim=True, unbiased=False)
    return (x - m) / torch.sqrt(v + eps)
def _scatter_add(tgt, idx, src, axis=0):
    return tgt.clone().index_add_(axis, idx, src)
def _segment_sum(src, seg, n):
    out = torch.zeros((n,) + src.shape[1:], dtype=src.dtype)
    return out.index_add_(0, seg, src)
def _pad(x, pw):
    flat = tuple(v for pair in reversed(pw) for v in pair)
    return torch.nn.functional.pad(x, flat)

kernel_name = 'parallel_sum__ssm_conv_s4d__mixer_channel_mlp__prompt'

def setup_inputs():

    _w = (lambda a: (lambda t: t.to(torch.bfloat16) if t.is_floating_point() else t)(torch.as_tensor(a)))
    def _A_setup():
        Bsz, L, D, N = 1, 2048, 512, 128
        return {
            "u": _w((lambda *s: torch.randn(*s, dtype=torch.bfloat16) * 0.05)(Bsz, L, D)),
            "log_A_real": _w((lambda *s: torch.randn(*s, dtype=torch.bfloat16) * 3.2)(D, N) * 0.5),
            "A_imag": _w((lambda *s: torch.randn(*s, dtype=torch.bfloat16) * 0.05)(D, N) * 3.14),
            "C_real": _w((lambda *s: torch.randn(*s, dtype=torch.bfloat16) * 0.1)(D, N) / N ** 0.5),
            "C_imag": _w((lambda *s: torch.randn(*s, dtype=torch.bfloat16) * 0.2)(D, N) / N ** 0.5),
            "log_dt": _w((lambda *s: torch.randn(*s, dtype=torch.bfloat16) * 0.05)(D) * 0.5 - 4.0),
            "D_skip": _w((lambda *s: torch.randn(*s, dtype=torch.bfloat16) * 0.05)(D)),
        }
    _A_in = _A_setup()

    def _B_setup():
        B, S, D, F = 1, 2048, 512, 1376
        return {
            "x": _w((lambda *s: torch.randn(*s, dtype=torch.bfloat16) * 0.05)(B, S, D)),
            "w1": _w((lambda *s: torch.randn(*s, dtype=torch.bfloat16) * 1.6)(D, F) * (D ** -0.5)),
            "b1": _w((lambda *s: torch.randn(*s, dtype=torch.bfloat16) * 0.8)(F)),
            "w2": _w((lambda *s: torch.randn(*s, dtype=torch.bfloat16) * 0.05)(F, D) * (F ** -0.5)),
            "b2": _w((lambda *s: torch.randn(*s, dtype=torch.bfloat16) * 0.05)(D)),
        }
    _B_in = _B_setup()

    return {
        "A_u": _A_in["u"],
        "A_log_A_real": _A_in["log_A_real"],
        "A_A_imag": _A_in["A_imag"],
        "A_C_real": _A_in["C_real"],
        "A_C_imag": _A_in["C_imag"],
        "A_log_dt": _A_in["log_dt"],
        "A_D_skip": _A_in["D_skip"],
        "B_x": _B_in["x"],
        "B_w1": _B_in["w1"],
        "B_b1": _B_in["b1"],
        "B_w2": _B_in["w2"],
        "B_b2": _B_in["b2"],
    }

def reference(A_u, A_log_A_real, A_A_imag, A_C_real, A_C_imag, A_log_dt, A_D_skip, B_x, B_w1, B_b1, B_w2, B_b2):
    def _A_ref(u, log_A_real, A_imag, C_real, C_imag, log_dt, D_skip):
        L = u.shape[1]
        dt = torch.exp(log_dt)
        A = -torch.exp(log_A_real) + 1j * A_imag
        C = (C_real + 1j * C_imag) * dt[:, None]
        pos = (lambda x, dt: x.to(dt))(torch.arange(L), log_dt.dtype)
        P = torch.exp((A * dt[:, None])[:, :, None] * pos[None, None, :])
        K = 2.0 * torch.einsum("dn,dnl->dl", C, P).real
        L2 = 2 * L
        u_t = (lambda x, *d: x.permute(*d))(u, 0, 2, 1)
        Kf = (lambda x, *a, **k: torch.fft.rfft(x.float(), *a, **k))(K, L2)
        Uf = (lambda x, *a, **k: torch.fft.rfft(x.float(), *a, **k))(u_t, L2)
        y = (lambda x, *a, **k: torch.fft.irfft(x, *a, **k).to(torch.bfloat16))(Uf * Kf[None, :, :], L2)[:, :, :L]
        y = (lambda x, *d: x.permute(*d))(y, 0, 2, 1)
        return y + u * D_skip[None, None, :]

    def _B_ref(x, w1, b1, w2, b2):
        y = _layernorm(x, axis=-1)
        h = _gelu(torch.einsum("bsd,df->bsf", y, w1) + b1)
        return torch.einsum("bsf,fd->bsd", h, w2) + b2

    x = A_u
    xn = _layernorm(x, axis=-1)
    return x + _A_ref(xn, A_log_A_real, A_A_imag, A_C_real, A_C_imag, A_log_dt, A_D_skip) + _B_ref(xn, B_w1, B_b1, B_w2, B_b2)
```

```asm
; @launch grid=(256,1,1) block=(512,1,1) lds=161792
.amdgcn_target "amdgcn-amd-amdhsa--gfx950"
.text
.globl parallel_sum__ssm_conv_s4d__mixer_channel_mlp__prompt_kernel
.p2align 8
.type parallel_sum__ssm_conv_s4d__mixer_channel_mlp__prompt_kernel,@function
parallel_sum__ssm_conv_s4d__mixer_channel_mlp__prompt_kernel:
L_kstart:
    s_getpc_b64 s[64:65]
L_pcref:
    s_sub_u32 s64, s64, L_pcref-L_kstart
    s_subb_u32 s65, s65, 0
    s_lshr_b32 s66, s2, 3
    s_and_b32 s66, s66, 31
    s_mul_i32 s66, s66, 10
    v_add_u32 v1, s66, v0
    v_lshlrev_b32 v1, 7, v1
    v_min_u32 v1, L_kend-L_kstart-4, v1
    v_cmp_gt_u32 vcc, 10, v0
    s_nop 2
    s_and_saveexec_b64 s[66:67], vcc
    s_cbranch_execz Lcp_1
    global_load_dword v255, v1, s[64:65]
Lcp_1:
    s_mov_b64 exec, s[66:67]
    s_load_dwordx16 s[4:19], s[0:1], 0
    s_load_dwordx8 s[20:27], s[0:1], 64
    s_load_dwordx4 s[28:31], s[0:1], 96
    s_load_dwordx2 s[32:33], s[0:1], 112
    s_cmp_ge_u32 s2, 256
    s_cbranch_scc1 L_end
    v_lshrrev_b32 v1, 6, v0
    v_and_b32 v0, 63, v0
    v_readfirstlane_b32 s3, v1
    s_and_b32 s62, s2, 7
    s_lshr_b32 s63, s2, 3
    s_lshr_b32 s52, s62, 1
    s_lshl_b32 s52, s52, 3
    s_and_b32 s64, s63, 7
    s_add_u32 s52, s52, s64
    s_and_b32 s53, s62, 1
    s_lshl_b32 s53, s53, 2
    s_lshr_b32 s64, s63, 3
    s_add_u32 s53, s53, s64
    s_mul_i32 s54, s53, 43
    s_add_u32 s55, s54, 48
    s_add_u32 s54, s54, 5
    s_lshr_b32 s54, s54, 3
    s_lshr_b32 s55, s55, 3
    s_sub_u32 s55, s55, s54
    s_lshl_b32 s56, s53, 1
    s_add_u32 s56, s56, s52
    s_and_b32 s56, s56, 7
    s_waitcnt lgkmcnt(0)
    s_cmp_ge_u32 s3, 4
    s_cbranch_scc1 L_hp0
    s_mov_b32 s36, s4
    s_and_b32 s37, s5, 0xffff
    s_mov_b32 s38, 2097152
    s_mov_b32 s39, 0x20000
    s_mov_b32 s40, s20
    s_and_b32 s41, s21, 0xffff
    s_mov_b32 s42, 1409024
    s_mov_b32 s43, 0x20000
    s_barrier
    s_branch L_g1
L_hp0:
    s_setprio 2
    s_sub_u32 s61, s3, 4
    s_lshr_b32 s62, s61, 1
    s_lshl_b32 s76, s2, 1
    s_add_u32 s76, s76, s62
    s_and_b32 s77, s61, 1
    s_lshl_b32 s62, s76, 8
    s_lshl_b32 s63, s77, 7
    s_add_u32 s62, s62, s63
    v_lshl_add_u32 v13, v0, 1, s62
    s_lshl_b32 s62, s76, 1
    v_mov_b32 v14, s62
    global_load_ushort v8, v13, s[6:7]
    global_load_ushort v9, v13, s[8:9]
    global_load_ushort v10, v13, s[10:11]
    global_load_ushort v11, v13, s[12:13]
    global_load_ushort v12, v14, s[14:15]
    s_lshl_b32 s62, s61, 6
    v_add_u32 v145, s62, v0
    s_lshl_b32 s63, s54, 5
    v_add_u32 v146, s63, v145
    v_min_u32 v146, 1375, v146
    v_lshlrev_b32 v146, 1, v146
    global_load_ushort v146, v146, s[22:23]
    s_lshl_b32 s62, s76, 1
    v_mov_b32 v147, s62
    global_load_ushort v147, v147, s[16:17]
    s_barrier
    s_branch L_helper
L_g1:
    s_lshl_b32 s62, s52, 16
    s_lshl_b32 s63, s3, 14
    s_add_u32 s62, s62, s63
    s_add_u32 s63, s63, 34816
    s_lshl_b32 s65, s56, 3
    s_and_b32 s64, s53, 1
    s_lshl_b32 s64, s64, 3
    s_xor_b32 s66, s64, 0
    v_xor_b32 v1, s66, v0
    s_lshl_b32 s66, s66, 10
    v_add_u32 v1, s65, v1
    s_add_u32 m0, s63, s66
    v_and_b32 v1, 63, v1
    s_add_u32 s67, s62, s66
    v_lshlrev_b32 v1, 4, v1
    buffer_load_dwordx4 v1, s[36:39], s67 offen lds
    s_xor_b32 s66, s64, 1
    v_xor_b32 v2, s66, v0
    s_lshl_b32 s66, s66, 10
    v_add_u32 v2, s65, v2
    s_add_u32 m0, s63, s66
    v_and_b32 v2, 63, v2
    s_add_u32 s67, s62, s66
    v_lshlrev_b32 v2, 4, v2
    buffer_load_dwordx4 v2, s[36:39], s67 offen lds
    s_xor_b32 s66, s64, 2
    v_xor_b32 v1, s66, v0
    s_lshl_b32 s66, s66, 10
    v_add_u32 v1, s65, v1
    s_add_u32 m0, s63, s66
    v_and_b32 v1, 63, v1
    s_add_u32 s67, s62, s66
    v_lshlrev_b32 v1, 4, v1
    buffer_load_dwordx4 v1, s[36:39], s67 offen lds
    s_xor_b32 s66, s64, 3
    v_xor_b32 v2, s66, v0
    s_lshl_b32 s66, s66, 10
    v_add_u32 v2, s65, v2
    s_add_u32 m0, s63, s66
    v_and_b32 v2, 63, v2
    s_add_u32 s67, s62, s66
    v_lshlrev_b32 v2, 4, v2
    buffer_load_dwordx4 v2, s[36:39], s67 offen lds
    s_xor_b32 s66, s64, 4
    v_xor_b32 v1, s66, v0
    s_lshl_b32 s66, s66, 10
    v_add_u32 v1, s65, v1
    s_add_u32 m0, s63, s66
    v_and_b32 v1, 63, v1
    s_add_u32 s67, s62, s66
    v_lshlrev_b32 v1, 4, v1
    buffer_load_dwordx4 v1, s[36:39], s67 offen lds
    s_xor_b32 s66, s64, 5
    v_xor_b32 v2, s66, v0
    s_lshl_b32 s66, s66, 10
    v_add_u32 v2, s65, v2
    s_add_u32 m0, s63, s66
    v_and_b32 v2, 63, v2
    s_add_u32 s67, s62, s66
    v_lshlrev_b32 v2, 4, v2
    buffer_load_dwordx4 v2, s[36:39], s67 offen lds
    s_xor_b32 s66, s64, 6
    v_xor_b32 v1, s66, v0
    s_lshl_b32 s66, s66, 10
    v_add_u32 v1, s65, v1
    s_add_u32 m0, s63, s66
    v_and_b32 v1, 63, v1
    s_add_u32 s67, s62, s66
    v_lshlrev_b32 v1, 4, v1
    buffer_load_dwordx4 v1, s[36:39], s67 offen lds
    s_xor_b32 s66, s64, 7
    v_xor_b32 v2, s66, v0
    s_lshl_b32 s66, s66, 10
    v_add_u32 v2, s65, v2
    s_add_u32 m0, s63, s66
    v_and_b32 v2, 63, v2
    s_add_u32 s67, s62, s66
    v_lshlrev_b32 v2, 4, v2
    buffer_load_dwordx4 v2, s[36:39], s67 offen lds
    s_xor_b32 s66, s64, 8
    v_xor_b32 v1, s66, v0
    s_lshl_b32 s66, s66, 10
    v_add_u32 v1, s65, v1
    s_add_u32 m0, s63, s66
    v_and_b32 v1, 63, v1
    s_add_u32 s67, s62, s66
    v_lshlrev_b32 v1, 4, v1
    buffer_load_dwordx4 v1, s[36:39], s67 offen lds
    s_xor_b32 s66, s64, 9
    v_xor_b32 v2, s66, v0
    s_lshl_b32 s66, s66, 10
    v_add_u32 v2, s65, v2
    s_add_u32 m0, s63, s66
    v_and_b32 v2, 63, v2
    s_add_u32 s67, s62, s66
    v_lshlrev_b32 v2, 4, v2
    buffer_load_dwordx4 v2, s[36:39], s67 offen lds
    s_xor_b32 s66, s64, 10
    v_xor_b32 v1, s66, v0
    s_lshl_b32 s66, s66, 10
    v_add_u32 v1, s65, v1
    s_add_u32 m0, s63, s66
    v_and_b32 v1, 63, v1
    s_add_u32 s67, s62, s66
    v_lshlrev_b32 v1, 4, v1
    buffer_load_dwordx4 v1, s[36:39], s67 offen lds
    s_xor_b32 s66, s64, 11
    v_xor_b32 v2, s66, v0
    s_lshl_b32 s66, s66, 10
    v_add_u32 v2, s65, v2
    s_add_u32 m0, s63, s66
    v_and_b32 v2, 63, v2
    s_add_u32 s67, s62, s66
    v_lshlrev_b32 v2, 4, v2
    buffer_load_dwordx4 v2, s[36:39], s67 offen lds
    s_xor_b32 s66, s64, 12
    v_xor_b32 v1, s66, v0
    s_lshl_b32 s66, s66, 10
    v_add_u32 v1, s65, v1
    s_add_u32 m0, s63, s66
    v_and_b32 v1, 63, v1
    s_add_u32 s67, s62, s66
    v_lshlrev_b32 v1, 4, v1
    buffer_load_dwordx4 v1, s[36:39], s67 offen lds
    s_xor_b32 s66, s64, 13
    v_xor_b32 v2, s66, v0
    s_lshl_b32 s66, s66, 10
    v_add_u32 v2, s65, v2
    s_add_u32 m0, s63, s66
    v_and_b32 v2, 63, v2
    s_add_u32 s67, s62, s66
    v_lshlrev_b32 v2, 4, v2
    buffer_load_dwordx4 v2, s[36:39], s67 offen lds
    s_xor_b32 s66, s64, 14
    v_xor_b32 v1, s66, v0
    s_lshl_b32 s66, s66, 10
    v_add_u32 v1, s65, v1
    s_add_u32 m0, s63, s66
    v_and_b32 v1, 63, v1
    s_add_u32 s67, s62, s66
    v_lshlrev_b32 v1, 4, v1
    buffer_load_dwordx4 v1, s[36:39], s67 offen lds
    s_xor_b32 s66, s64, 15
    v_xor_b32 v2, s66, v0
    s_lshl_b32 s66, s66, 10
    v_add_u32 v2, s65, v2
    s_add_u32 m0, s63, s66
    v_and_b32 v2, 63, v2
    s_add_u32 s67, s62, s66
    v_lshlrev_b32 v2, 4, v2
    buffer_load_dwordx4 v2, s[36:39], s67 offen lds
    s_mov_b32 s44, s32
    s_and_b32 s45, s33, 0xffff
    s_mov_b32 s46, 16777216
    s_mov_b32 s47, 0x20000
    s_mov_b32 s48, s28
    s_and_b32 s49, s29, 0xffff
    s_mov_b32 s50, 2097152
    s_mov_b32 s51, 0x20000
    v_add_u32 v48, 0, v0
    v_mul_u32_u24 v49, 2731, v48
    v_lshrrev_b32 v49, 16, v49
    v_mul_u32_u24 v50, 24, v49
    v_sub_u32 v50, v48, v50
    v_lshrrev_b32 v51, 1, v49
    v_and_b32 v51, 3, v51
    v_lshlrev_b32 v51, 1, v51
    v_xor_b32 v50, v50, v51
    v_lshrrev_b32 v51, 2, v49
    v_lshlrev_b32 v51, 3, v51
    v_and_b32 v49, 3, v49
    v_add_u32 v49, v49, v51
    v_mul_u32_u24 v49, 2752, v49
    v_lshl_add_u32 v44, v50, 4, v49
    v_add_u32 v48, 64, v0
    v_mul_u32_u24 v49, 2731, v48
    v_lshrrev_b32 v49, 16, v49
    v_mul_u32_u24 v50, 24, v49
    v_sub_u32 v50, v48, v50
    v_lshrrev_b32 v51, 1, v49
    v_and_b32 v51, 3, v51
    v_lshlrev_b32 v51, 1, v51
    v_xor_b32 v50, v50, v51
    v_lshrrev_b32 v51, 2, v49
    v_lshlrev_b32 v51, 3, v51
    v_and_b32 v49, 3, v49
    v_add_u32 v49, v49, v51
    v_mul_u32_u24 v49, 2752, v49
    v_lshl_add_u32 v45, v50, 4, v49
    v_add_u32 v48, 128, v0
    v_mul_u32_u24 v49, 2731, v48
    v_lshrrev_b32 v49, 16, v49
    v_mul_u32_u24 v50, 24, v49
    v_sub_u32 v50, v48, v50
    v_lshrrev_b32 v51, 1, v49
    v_and_b32 v51, 3, v51
    v_lshlrev_b32 v51, 1, v51
    v_xor_b32 v50, v50, v51
    v_lshrrev_b32 v51, 2, v49
    v_lshlrev_b32 v51, 3, v51
    v_and_b32 v49, 3, v49
    v_add_u32 v49, v49, v51
    v_mul_u32_u24 v49, 2752, v49
    v_lshl_add_u32 v46, v50, 4, v49
    s_add_u32 s62, s56, 0
    s_and_b32 s62, s62, 7
    s_lshl_b32 s62, s62, 6
    s_lshr_b32 s63, s3, 1
    s_lshl_b32 s63, s63, 5
    s_add_u32 s62, s62, s63
    s_and_b32 s63, s3, 1
    s_lshl_b32 s63, s63, 2
    s_add_u32 s62, s62, s63
    s_mul_i32 s62, s62, 2752
    s_lshl_b32 s63, s54, 6
    s_add_u32 s62, s62, s63
    s_mul_i32 s64, s3, 6144
    s_add_u32 m0, s64, 100352
    s_nop 0
    buffer_load_dwordx4 v44, s[40:43], s62 offen lds
    s_add_u32 m0, s64, 101376
    s_nop 0
    buffer_load_dwordx4 v45, s[40:43], s62 offen lds
    s_add_u32 m0, s64, 102400
    s_nop 0
    buffer_load_dwordx4 v46, s[40:43], s62 offen lds
    s_add_u32 s62, s62, 44032
    s_add_u32 m0, s64, 103424
    s_nop 0
    buffer_load_dwordx4 v44, s[40:43], s62 offen lds
    s_add_u32 m0, s64, 104448
    s_nop 0
    buffer_load_dwordx4 v45, s[40:43], s62 offen lds
    s_add_u32 m0, s64, 105472
    s_nop 0
    buffer_load_dwordx4 v46, s[40:43], s62 offen lds
    s_and_b32 s57, s3, 1
    s_lshr_b32 s58, s3, 1
    s_lshl_b32 s59, s57, 1
    s_add_u32 s60, s59, 1
    s_sub_u32 s60, s60, s58
    s_add_u32 s59, s59, s58
    s_mov_b32 s70, 0xc0135761
    s_mov_b32 s71, 0xbdd2d3e8
    s_mov_b32 s72, 1.0
    s_mov_b32 s73, 1.0
    v_lshrrev_b32 v1, 2, v0
    v_mul_u32_u24 v2, 384, v1
    v_and_b32 v3, 3, v0
    v_lshl_add_u32 v2, v3, 3, v2
    v_lshrrev_b32 v3, 1, v1
    v_and_b32 v3, 3, v3
    s_mul_i32 s62, s58, 6
    s_add_u32 s64, s62, 0
    v_xor_b32 v14, s64, v3
    v_lshl_add_u32 v8, v14, 5, v2
    v_add_u32 v8, 100352, v8
    s_add_u32 s64, s62, 1
    v_xor_b32 v14, s64, v3
    v_lshl_add_u32 v9, v14, 5, v2
    v_add_u32 v9, 100352, v9
    s_add_u32 s64, s62, 2
    v_xor_b32 v14, s64, v3
    v_lshl_add_u32 v10, v14, 5, v2
    v_add_u32 v10, 100352, v10
    s_add_u32 s64, s62, 3
    v_xor_b32 v14, s64, v3
    v_lshl_add_u32 v11, v14, 5, v2
    v_add_u32 v11, 100352, v11
    s_add_u32 s64, s62, 4
    v_xor_b32 v14, s64, v3
    v_lshl_add_u32 v12, v14, 5, v2
    v_add_u32 v12, 100352, v12
    s_add_u32 s64, s62, 5
    v_xor_b32 v14, s64, v3
    v_lshl_add_u32 v13, v14, 5, v2
    v_add_u32 v13, 100352, v13
    v_mov_b32 v4, 0x3f803f80
    v_mov_b32 v5, 0x3f803f80
    v_mov_b32 v6, 0x3f803f80
    v_mov_b32 v7, 0x3f803f80
    v_mov_b32 v1, 152064
    v_lshl_add_u32 v1, v0, 2, v1
    v_mov_b32 v2, 0
    v_cmp_gt_u32 vcc, 56, v0
    s_nop 2
    s_and_saveexec_b64 s[74:75], vcc
    ds_write_b32 v1, v2
    s_mov_b64 exec, s[74:75]
    s_waitcnt lgkmcnt(0)
    s_waitcnt vmcnt(6)
    s_barrier
    s_setprio 0
    s_add_u32 s62, s56, 1
    s_and_b32 s62, s62, 7
    s_lshl_b32 s62, s62, 6
    s_lshr_b32 s63, s3, 1
    s_lshl_b32 s63, s63, 5
    s_add_u32 s62, s62, s63
    s_and_b32 s63, s3, 1
    s_lshl_b32 s63, s63, 2
    s_add_u32 s62, s62, s63
    s_mul_i32 s62, s62, 2752
    s_lshl_b32 s63, s54, 6
    s_add_u32 s62, s62, s63
    s_mul_i32 s64, s3, 6144
    s_add_u32 m0, s64, 124928
    s_nop 0
    buffer_load_dwordx4 v44, s[40:43], s62 offen lds
    s_add_u32 m0, s64, 125952
    s_nop 0
    buffer_load_dwordx4 v45, s[40:43], s62 offen lds
    s_add_u32 m0, s64, 126976
    s_nop 0
    buffer_load_dwordx4 v46, s[40:43], s62 offen lds
    s_add_u32 s62, s62, 44032
    s_add_u32 m0, s64, 128000
    s_nop 0
    buffer_load_dwordx4 v44, s[40:43], s62 offen lds
    s_add_u32 m0, s64, 129024
    s_nop 0
    buffer_load_dwordx4 v45, s[40:43], s62 offen lds
    s_add_u32 m0, s64, 130048
    s_nop 0
    buffer_load_dwordx4 v46, s[40:43], s62 offen lds
    v_and_b32 v1, 15, v0
    v_lshrrev_b32 v2, 4, v0
    v_lshlrev_b32 v3, 10, v1
    s_lshl_b32 s62, s59, 14
    s_lshl_b32 s63, s60, 14
    v_add_u32 v14, 0, v2
    v_xor_b32 v14, v14, v1
    v_lshl_add_u32 v14, v14, 4, v3
    v_add_u32 v20, s62, v14
    v_add_u32 v24, s63, v14
    v_add_u32 v14, 4, v2
    v_xor_b32 v14, v14, v1
    v_lshl_add_u32 v14, v14, 4, v3
    v_add_u32 v21, s62, v14
    v_add_u32 v25, s63, v14
    v_add_u32 v14, 8, v2
    v_xor_b32 v14, v14, v1
    v_lshl_add_u32 v14, v14, 4, v3
    v_add_u32 v22, s62, v14
    v_add_u32 v26, s63, v14
    v_add_u32 v14, 12, v2
    v_xor_b32 v14, v14, v1
    v_lshl_add_u32 v14, v14, 4, v3
    v_add_u32 v23, s62, v14
    v_add_u32 v27, s63, v14
    ds_read_b128 v[128:131], v20 offset:34816
    ds_read_b128 v[132:135], v21 offset:34816
    ds_read_b128 v[136:139], v22 offset:34816
    ds_read_b128 v[140:143], v23 offset:34816
    ds_read_b128 v[144:147], v20 offset:35072
    ds_read_b128 v[148:151], v21 offset:35072
    ds_read_b128 v[152:155], v22 offset:35072
    ds_read_b128 v[156:159], v23 offset:35072
    ds_read_b128 v[160:163], v20 offset:35328
    ds_read_b128 v[164:167], v21 offset:35328
    ds_read_b128 v[168:171], v22 offset:35328
    ds_read_b128 v[172:175], v23 offset:35328
    v_add_u32 v28, s62, v3
    s_sub_u32 s64, s53, s56
    s_and_b32 s64, s64, 7
    s_lshl_b32 s64, s64, 3
    v_lshlrev_b32 v29, 1, v2
    v_add_u32 v29, s64, v29
    v_xor_b32 v30, v29, v1
    v_add_u32 v29, 1, v29
    v_xor_b32 v31, v29, v1
    v_lshl_add_u32 v30, v30, 4, v28
    v_lshl_add_u32 v31, v31, 4, v28
    s_waitcnt lgkmcnt(4)
    ds_read_b128 v[176:179], v20 offset:35584
    ds_read_b128 v[180:183], v21 offset:35584
    ds_read_b128 v[184:187], v22 offset:35584
    ds_read_b128 v[188:191], v23 offset:35584
    ds_read_b128 v[88:91], v30 offset:34816
    ds_read_b128 v[92:95], v31 offset:34816
    v_mfma_f32_16x16x32_bf16 v[80:83], v[4:7], v[128:131], 0
    v_mfma_f32_16x16x32_bf16 v[84:87], v[128:131], v[128:131], 0
    v_mfma_f32_16x16x32_bf16 v[80:83], v[4:7], v[132:135], v[80:83]
    v_mfma_f32_16x16x32_bf16 v[84:87], v[132:135], v[132:135], v[84:87]
    v_mfma_f32_16x16x32_bf16 v[80:83], v[4:7], v[136:139], v[80:83]
    v_mfma_f32_16x16x32_bf16 v[84:87], v[136:139], v[136:139], v[84:87]
    v_mfma_f32_16x16x32_bf16 v[80:83], v[4:7], v[140:143], v[80:83]
    v_mfma_f32_16x16x32_bf16 v[84:87], v[140:143], v[140:143], v[84:87]
    s_waitcnt lgkmcnt(6)
    v_mfma_f32_16x16x32_bf16 v[80:83], v[4:7], v[144:147], v[80:83]
    v_mfma_f32_16x16x32_bf16 v[84:87], v[144:147], v[144:147], v[84:87]
    ds_read_b128 v[192:195], v24 offset:34816
    v_mfma_f32_16x16x32_bf16 v[80:83], v[4:7], v[148:151], v[80:83]
    v_mfma_f32_16x16x32_bf16 v[84:87], v[148:151], v[148:151], v[84:87]
    ds_read_b128 v[196:199], v25 offset:34816
    v_mfma_f32_16x16x32_bf16 v[80:83], v[4:7], v[152:155], v[80:83]
    v_mfma_f32_16x16x32_bf16 v[84:87], v[152:155], v[152:155], v[84:87]
    ds_read_b128 v[200:203], v26 offset:34816
    v_mfma_f32_16x16x32_bf16 v[80:83], v[4:7], v[156:159], v[80:83]
    v_mfma_f32_16x16x32_bf16 v[84:87], v[156:159], v[156:159], v[84:87]
    ds_read_b128 v[204:207], v27 offset:34816
    v_mfma_f32_16x16x32_bf16 v[80:83], v[4:7], v[160:163], v[80:83]
    v_mfma_f32_16x16x32_bf16 v[84:87], v[160:163], v[160:163], v[84:87]
    ds_read_b128 v[208:211], v24 offset:35072
    v_mfma_f32_16x16x32_bf16 v[80:83], v[4:7], v[164:167], v[80:83]
    v_mfma_f32_16x16x32_bf16 v[84:87], v[164:167], v[164:167], v[84:87]
    ds_read_b128 v[212:215], v25 offset:35072
    v_mfma_f32_16x16x32_bf16 v[80:83], v[4:7], v[168:171], v[80:83]
    v_mfma_f32_16x16x32_bf16 v[84:87], v[168:171], v[168:171], v[84:87]
    ds_read_b128 v[216:219], v26 offset:35072
    v_mfma_f32_16x16x32_bf16 v[80:83], v[4:7], v[172:175], v[80:83]
    v_mfma_f32_16x16x32_bf16 v[84:87], v[172:175], v[172:175], v[84:87]
    ds_read_b128 v[220:223], v27 offset:35072
    s_waitcnt lgkmcnt(10)
    v_mfma_f32_16x16x32_bf16 v[80:83], v[4:7], v[176:179], v[80:83]
    v_mfma_f32_16x16x32_bf16 v[84:87], v[176:179], v[176:179], v[84:87]
    ds_read_b128 v[224:227], v24 offset:35328
    v_mfma_f32_16x16x32_bf16 v[80:83], v[4:7], v[180:183], v[80:83]
    v_mfma_f32_16x16x32_bf16 v[84:87], v[180:183], v[180:183], v[84:87]
    ds_read_b128 v[228:231], v25 offset:35328
    v_mfma_f32_16x16x32_bf16 v[80:83], v[4:7], v[184:187], v[80:83]
    v_mfma_f32_16x16x32_bf16 v[84:87], v[184:187], v[184:187], v[84:87]
    ds_read_b128 v[232:235], v26 offset:35328
    v_mfma_f32_16x16x32_bf16 v[80:83], v[4:7], v[188:191], v[80:83]
    v_mfma_f32_16x16x32_bf16 v[84:87], v[188:191], v[188:191], v[84:87]
    ds_read_b128 v[236:239], v27 offset:35328
    s_waitcnt lgkmcnt(8)
    ds_read_b128 v[240:243], v24 offset:35584
    ds_read_b128 v[244:247], v25 offset:35584
    ds_read_b128 v[248:251], v26 offset:35584
    ds_read_b128 v[252:255], v27 offset:35584
    v_and_b32 v32, 3, v0
    v_lshrrev_b32 v34, 2, v1
    v_lshl_add_u32 v34, v34, 4, v1
    v_lshlrev_b32 v34, 2, v34
    v_cmp_eq_u32 vcc, 1, v32
    s_nop 1
    v_cndmask_b32 v33, v84, v85, vcc
    v_cmp_eq_u32 vcc, 2, v32
    s_nop 1
    v_cndmask_b32 v33, v33, v86, vcc
    v_cmp_eq_u32 vcc, 3, v32
    s_nop 1
    v_cndmask_b32 v33, v33, v87, vcc
    ds_bpermute_b32 v33, v34, v33
    v_lshlrev_b32 v44, 16, v88
    v_and_b32 v45, 0xffff0000, v88
    v_lshlrev_b32 v46, 16, v89
    v_and_b32 v47, 0xffff0000, v89
    v_lshlrev_b32 v48, 16, v90
    v_and_b32 v49, 0xffff0000, v90
    v_lshlrev_b32 v50, 16, v91
    v_and_b32 v51, 0xffff0000, v91
    v_lshlrev_b32 v52, 16, v92
    v_and_b32 v53, 0xffff0000, v92
    v_lshlrev_b32 v54, 16, v93
    v_and_b32 v55, 0xffff0000, v93
    v_lshlrev_b32 v56, 16, v94
    v_and_b32 v57, 0xffff0000, v94
    v_lshlrev_b32 v58, 16, v95
    v_and_b32 v59, 0xffff0000, v95
    s_waitcnt lgkmcnt(0)
    v_mul_f32 v60, 0x3b000000, v80
    v_mul_f32 v34, 0x3b000000, v33
    v_fma_f32 v34, -v60, v60, v34
    v_max_f32 v34, 0, v34
    v_cvt_pk_bf16_f32 v62, v60, v60
    v_and_b32 v62, 0xffff0000, v62
    v_cvt_pk_bf16_f32 v35, v34, v34
    v_and_b32 v35, 0xffff0000, v35
    v_add_f32 v35, 0x3727c5ac, v35
    v_cvt_pk_bf16_f32 v35, v35, v35
    v_and_b32 v35, 0xffff0000, v35
    v_sqrt_f32 v35, v35
    s_nop 0
    v_cvt_pk_bf16_f32 v35, v35, v35
    v_and_b32 v35, 0xffff0000, v35
    v_rcp_f32 v63, v35
    s_nop 0
    v_mul_f32 v34, v34, v63
    v_mul_f32 v34, v34, v63
    v_cvt_pk_bf16_f32 v34, v34, v34
    v_and_b32 v34, 0xffff0000, v34
    v_add_f32 v34, 0x3727c5ac, v34
    v_cvt_pk_bf16_f32 v34, v34, v34
    v_and_b32 v34, 0xffff0000, v34
    v_sqrt_f32 v34, v34
    s_nop 0
    v_cvt_pk_bf16_f32 v34, v34, v34
    v_and_b32 v34, 0xffff0000, v34
    v_rcp_f32 v34, v34
    s_nop 0
    v_mul_f32 v61, v63, v34
    s_lshl_b32 s62, s59, 8
    s_add_u32 s62, s62, 149504
    v_lshl_add_u32 v32, v1, 4, s62
    v_cmp_gt_u32 vcc, 16, v0
    s_nop 2
    s_and_saveexec_b64 s[74:75], vcc
    ds_write_b64 v32, v[60:61]
    s_mov_b64 exec, s[74:75]
    v_lshrrev_b32 v32, 1, v1
    v_and_b32 v32, 3, v32
    v_xor_b32 v32, v32, v2
    v_lshlrev_b32 v32, 5, v32
    v_lshl_add_u32 v32, v1, 7, v32
    s_lshl_b32 s62, s59, 11
    s_add_u32 s62, s62, 152576
    v_add_u32 v32, s62, v32
    v_sub_f32 v44, v44, v62
    v_sub_f32 v45, v45, v62
    v_sub_f32 v46, v46, v62
    v_sub_f32 v47, v47, v62
    v_sub_f32 v48, v48, v62
    v_sub_f32 v49, v49, v62
    v_sub_f32 v50, v50, v62
    v_sub_f32 v51, v51, v62
    v_sub_f32 v52, v52, v62
    v_sub_f32 v53, v53, v62
    v_sub_f32 v54, v54, v62
    v_sub_f32 v55, v55, v62
    v_sub_f32 v56, v56, v62
    v_sub_f32 v57, v57, v62
    v_sub_f32 v58, v58, v62
    v_sub_f32 v59, v59, v62
    v_cvt_pk_bf16_f32 v88, v44, v45
    v_cvt_pk_bf16_f32 v89, v46, v47
    v_cvt_pk_bf16_f32 v90, v48, v49
    v_cvt_pk_bf16_f32 v91, v50, v51
    v_cvt_pk_bf16_f32 v92, v52, v53
    v_cvt_pk_bf16_f32 v93, v54, v55
    v_cvt_pk_bf16_f32 v94, v56, v57
    v_cvt_pk_bf16_f32 v95, v58, v59
    v_lshlrev_b32 v44, 16, v88
    v_and_b32 v45, 0xffff0000, v88
    v_lshlrev_b32 v46, 16, v89
    v_and_b32 v47, 0xffff0000, v89
    v_lshlrev_b32 v48, 16, v90
    v_and_b32 v49, 0xffff0000, v90
    v_lshlrev_b32 v50, 16, v91
    v_and_b32 v51, 0xffff0000, v91
    v_lshlrev_b32 v52, 16, v92
    v_and_b32 v53, 0xffff0000, v92
    v_lshlrev_b32 v54, 16, v93
    v_and_b32 v55, 0xffff0000, v93
    v_lshlrev_b32 v56, 16, v94
    v_and_b32 v57, 0xffff0000, v94
    v_lshlrev_b32 v58, 16, v95
    v_and_b32 v59, 0xffff0000, v95
    v_mul_f32 v44, v44, v63
    v_mul_f32 v45, v45, v63
    v_mul_f32 v46, v46, v63
    v_mul_f32 v47, v47, v63
    v_mul_f32 v48, v48, v63
    v_mul_f32 v49, v49, v63
    v_mul_f32 v50, v50, v63
    v_mul_f32 v51, v51, v63
    v_mul_f32 v52, v52, v63
    v_mul_f32 v53, v53, v63
    v_mul_f32 v54, v54, v63
    v_mul_f32 v55, v55, v63
    v_mul_f32 v56, v56, v63
    v_mul_f32 v57, v57, v63
    v_mul_f32 v58, v58, v63
    v_mul_f32 v59, v59, v63
    v_cvt_pk_bf16_f32 v88, v44, v45
    v_cvt_pk_bf16_f32 v89, v46, v47
    v_cvt_pk_bf16_f32 v90, v48, v49
    v_cvt_pk_bf16_f32 v91, v50, v51
    v_cvt_pk_bf16_f32 v92, v52, v53
    v_cvt_pk_bf16_f32 v93, v54, v55
    v_cvt_pk_bf16_f32 v94, v56, v57
    v_cvt_pk_bf16_f32 v95, v58, v59
    ds_write_b128 v32, v[88:91]
    ds_write_b128 v32, v[92:95] offset:16
    s_waitcnt lgkmcnt(0)
    s_waitcnt vmcnt(0)
    s_barrier
    s_setprio 1
    ds_read_b64_tr_b16 v[20:21], v8 offset:0
    ds_read_b64_tr_b16 v[22:23], v8 offset:6144
    ds_read_b64_tr_b16 v[24:25], v9 offset:0
    ds_read_b64_tr_b16 v[26:27], v9 offset:6144
    ds_read_b64_tr_b16 v[28:29], v10 offset:0
    ds_read_b64_tr_b16 v[30:31], v10 offset:6144
    ds_read_b64_tr_b16 v[32:33], v11 offset:0
    ds_read_b64_tr_b16 v[34:35], v11 offset:6144
    ds_read_b64_tr_b16 v[36:37], v12 offset:0
    ds_read_b64_tr_b16 v[38:39], v12 offset:6144
    ds_read_b64_tr_b16 v[40:41], v13 offset:0
    ds_read_b64_tr_b16 v[42:43], v13 offset:6144
    v_lshrrev_b32 v44, 4, v0
    v_and_b32 v45, 15, v0
    v_lshrrev_b32 v46, 2, v45
    v_and_b32 v47, 3, v0
    v_lshl_add_u32 v48, v44, 3, v46
    v_lshlrev_b32 v48, 7, v48
    v_lshl_add_u32 v48, v47, 3, v48
    v_add_u32 v48, 152576, v48
    v_lshrrev_b32 v49, 1, v46
    v_xor_b32 v50, s3, v49
    v_lshl_add_u32 v50, v50, 5, v48
    v_add_u32 v49, 2, v49
    v_xor_b32 v51, s3, v49
    v_lshl_add_u32 v51, v51, 5, v48
    ds_read_b64_tr_b16 v[56:57], v50 offset:0
    ds_read_b64_tr_b16 v[58:59], v51 offset:512
    ds_read_b64_tr_b16 v[60:61], v50 offset:4096
    ds_read_b64_tr_b16 v[62:63], v51 offset:4608
    v_lshlrev_b32 v52, 12, v45
    v_lshl_add_u32 v52, v44, 4, v52
    s_lshl_b32 s62, s53, 6
    s_lshl_b32 s63, s3, 4
    s_add_u32 s62, s62, s63
    s_lshl_b32 s62, s62, 12
    s_lshl_b32 s63, s52, 7
    s_add_u32 s62, s62, s63
    s_add_u32 s62, s62, 8388608
    s_waitcnt lgkmcnt(0)
    buffer_store_dwordx4 v[56:59], v52, s[44:47], s62 offen sc1
    buffer_store_dwordx4 v[60:63], v52, s[44:47], s62 offen offset:64 sc1
    v_mov_b32 v19, 152064
    v_mov_b32 v3, 1
    s_cmp_eq_u32 s57, 1
    s_cbranch_scc1 L_gl1
    s_barrier
    s_waitcnt lgkmcnt(0)
    v_mfma_f32_16x16x32_bf16 v[80:83], v[20:23], v[128:131], 0
    ds_read_b64_tr_b16 v[44:45], v8 offset:12288
    v_mfma_f32_16x16x32_bf16 v[84:87], v[20:23], v[192:195], 0
    ds_read_b64_tr_b16 v[46:47], v8 offset:18432
    v_mfma_f32_16x16x32_bf16 v[68:71], v[20:23], v[4:7], 0
    ds_read_b64_tr_b16 v[48:49], v9 offset:12288
    v_mfma_f32_16x16x32_bf16 v[88:91], v[24:27], v[128:131], 0
    ds_read_b64_tr_b16 v[50:51], v9 offset:18432
    v_mfma_f32_16x16x32_bf16 v[92:95], v[24:27], v[192:195], 0
    ds_read_b64_tr_b16 v[52:53], v10 offset:12288
    v_mfma_f32_16x16x32_bf16 v[72:75], v[24:27], v[4:7], 0
    ds_read_b64_tr_b16 v[54:55], v10 offset:18432
    v_mfma_f32_16x16x32_bf16 v[96:99], v[28:31], v[128:131], 0
    ds_read_b64_tr_b16 v[56:57], v11 offset:12288
    v_mfma_f32_16x16x32_bf16 v[100:103], v[28:31], v[192:195], 0
    ds_read_b64_tr_b16 v[58:59], v11 offset:18432
    v_mfma_f32_16x16x32_bf16 v[76:79], v[28:31], v[4:7], 0
    ds_read_b64_tr_b16 v[60:61], v12 offset:12288
    v_mfma_f32_16x16x32_bf16 v[104:107], v[32:35], v[128:131], 0
    ds_read_b64_tr_b16 v[62:63], v12 offset:18432
    v_mfma_f32_16x16x32_bf16 v[108:111], v[32:35], v[192:195], 0
    ds_read_b64_tr_b16 v[64:65], v13 offset:12288
    v_mfma_f32_16x16x32_bf16 v[112:115], v[36:39], v[128:131], 0
    ds_read_b64_tr_b16 v[66:67], v13 offset:18432
    v_mfma_f32_16x16x32_bf16 v[116:119], v[36:39], v[192:195], 0
    v_mfma_f32_16x16x32_bf16 v[120:123], v[40:43], v[128:131], 0
    v_mfma_f32_16x16x32_bf16 v[124:127], v[40:43], v[192:195], 0
    s_waitcnt lgkmcnt(0)
    v_mfma_f32_16x16x32_bf16 v[80:83], v[44:47], v[132:135], v[80:83]
    v_add_u32 v8, 0x6000, v8
    ds_read_b64_tr_b16 v[20:21], v8 offset:0
    v_mfma_f32_16x16x32_bf16 v[84:87], v[44:47], v[196:199], v[84:87]
    ds_read_b64_tr_b16 v[22:23], v8 offset:6144
    v_add_u32 v9, 0x6000, v9
    v_mfma_f32_16x16x32_bf16 v[68:71], v[44:47], v[4:7], v[68:71]
    ds_read_b64_tr_b16 v[24:25], v9 offset:0
    ds_read_b64_tr_b16 v[26:27], v9 offset:6144
    v_mfma_f32_16x16x32_bf16 v[88:91], v[48:51], v[132:135], v[88:91]
    v_add_u32 v10, 0x6000, v10
    v_mfma_f32_16x16x32_bf16 v[92:95], v[48:51], v[196:199], v[92:95]
    ds_read_b64_tr_b16 v[28:29], v10 offset:0
    v_mfma_f32_16x16x32_bf16 v[72:75], v[48:51], v[4:7], v[72:75]
    ds_read_b64_tr_b16 v[30:31], v10 offset:6144
    v_mfma_f32_16x16x32_bf16 v[96:99], v[52:55], v[132:135], v[96:99]
    v_add_u32 v11, 0x6000, v11
    v_mfma_f32_16x16x32_bf16 v[100:103], v[52:55], v[196:199], v[100:103]
    ds_read_b64_tr_b16 v[32:33], v11 offset:0
    v_mfma_f32_16x16x32_bf16 v[76:79], v[52:55], v[4:7], v[76:79]
    ds_read_b64_tr_b16 v[34:35], v11 offset:6144
    v_mfma_f32_16x16x32_bf16 v[104:107], v[56:59], v[132:135], v[104:107]
    v_add_u32 v12, 0x6000, v12
    v_mfma_f32_16x16x32_bf16 v[108:111], v[56:59], v[196:199], v[108:111]
    ds_read_b64_tr_b16 v[36:37], v12 offset:0
    v_mfma_f32_16x16x32_bf16 v[112:115], v[60:63], v[132:135], v[112:115]
    ds_read_b64_tr_b16 v[38:39], v12 offset:6144
    v_mfma_f32_16x16x32_bf16 v[116:119], v[60:63], v[196:199], v[116:119]
    v_add_u32 v13, 0x6000, v13
    v_mfma_f32_16x16x32_bf16 v[120:123], v[64:67], v[132:135], v[120:123]
    ds_read_b64_tr_b16 v[40:41], v13 offset:0
    v_mfma_f32_16x16x32_bf16 v[124:127], v[64:67], v[196:199], v[124:127]
    ds_read_b64_tr_b16 v[42:43], v13 offset:6144
    s_barrier
    s_waitcnt lgkmcnt(0)
    v_mfma_f32_16x16x32_bf16 v[80:83], v[20:23], v[136:139], v[80:83]
    ds_read_b64_tr_b16 v[44:45], v8 offset:12288
    v_mfma_f32_16x16x32_bf16 v[84:87], v[20:23], v[200:203], v[84:87]
    ds_read_b64_tr_b16 v[46:47], v8 offset:18432
    v_mfma_f32_16x16x32_bf16 v[68:71], v[20:23], v[4:7], v[68:71]
    ds_read_b64_tr_b16 v[48:49], v9 offset:12288
    v_mfma_f32_16x16x32_bf16 v[88:91], v[24:27], v[136:139], v[88:91]
    ds_read_b64_tr_b16 v[50:51], v9 offset:18432
    v_mfma_f32_16x16x32_bf16 v[92:95], v[24:27], v[200:203], v[92:95]
    ds_read_b64_tr_b16 v[52:53], v10 offset:12288
    v_mfma_f32_16x16x32_bf16 v[72:75], v[24:27], v[4:7], v[72:75]
    ds_read_b64_tr_b16 v[54:55], v10 offset:18432
    v_mfma_f32_16x16x32_bf16 v[96:99], v[28:31], v[136:139], v[96:99]
    ds_read_b64_tr_b16 v[56:57], v11 offset:12288
    v_mfma_f32_16x16x32_bf16 v[100:103], v[28:31], v[200:203], v[100:103]
    ds_read_b64_tr_b16 v[58:59], v11 offset:18432
    v_mfma_f32_16x16x32_bf16 v[76:79], v[28:31], v[4:7], v[76:79]
    ds_read_b64_tr_b16 v[60:61], v12 offset:12288
    v_mfma_f32_16x16x32_bf16 v[104:107], v[32:35], v[136:139], v[104:107]
    ds_read_b64_tr_b16 v[62:63], v12 offset:18432
    v_mfma_f32_16x16x32_bf16 v[108:111], v[32:35], v[200:203], v[108:111]
    ds_read_b64_tr_b16 v[64:65], v13 offset:12288
    v_mfma_f32_16x16x32_bf16 v[112:115], v[36:39], v[136:139], v[112:115]
    ds_read_b64_tr_b16 v[66:67], v13 offset:18432
    v_mfma_f32_16x16x32_bf16 v[116:119], v[36:39], v[200:203], v[116:119]
    v_mfma_f32_16x16x32_bf16 v[120:123], v[40:43], v[136:139], v[120:123]
    v_mfma_f32_16x16x32_bf16 v[124:127], v[40:43], v[200:203], v[124:127]
    s_waitcnt lgkmcnt(0)
    v_mfma_f32_16x16x32_bf16 v[80:83], v[44:47], v[140:143], v[80:83]
    v_add_u32 v8, 0xfffea000, v8
    ds_read_b64_tr_b16 v[20:21], v8 offset:0
    v_mfma_f32_16x16x32_bf16 v[84:87], v[44:47], v[204:207], v[84:87]
    ds_read_b64_tr_b16 v[22:23], v8 offset:6144
    v_add_u32 v9, 0xfffea000, v9
    v_mfma_f32_16x16x32_bf16 v[68:71], v[44:47], v[4:7], v[68:71]
    ds_read_b64_tr_b16 v[24:25], v9 offset:0
    ds_read_b64_tr_b16 v[26:27], v9 offset:6144
    v_mfma_f32_16x16x32_bf16 v[88:91], v[48:51], v[140:143], v[88:91]
    v_add_u32 v10, 0xfffea000, v10
    v_mfma_f32_16x16x32_bf16 v[92:95], v[48:51], v[204:207], v[92:95]
    ds_read_b64_tr_b16 v[28:29], v10 offset:0
    v_mfma_f32_16x16x32_bf16 v[72:75], v[48:51], v[4:7], v[72:75]
    ds_read_b64_tr_b16 v[30:31], v10 offset:6144
    v_mfma_f32_16x16x32_bf16 v[96:99], v[52:55], v[140:143], v[96:99]
    v_add_u32 v11, 0xfffea000, v11
    v_mfma_f32_16x16x32_bf16 v[100:103], v[52:55], v[204:207], v[100:103]
    ds_read_b64_tr_b16 v[32:33], v11 offset:0
    v_mfma_f32_16x16x32_bf16 v[76:79], v[52:55], v[4:7], v[76:79]
    ds_read_b64_tr_b16 v[34:35], v11 offset:6144
    v_mfma_f32_16x16x32_bf16 v[104:107], v[56:59], v[140:143], v[104:107]
    v_add_u32 v12, 0xfffea000, v12
    v_mfma_f32_16x16x32_bf16 v[108:111], v[56:59], v[204:207], v[108:111]
    ds_read_b64_tr_b16 v[36:37], v12 offset:0
    v_mfma_f32_16x16x32_bf16 v[112:115], v[60:63], v[140:143], v[112:115]
    ds_read_b64_tr_b16 v[38:39], v12 offset:6144
    v_mfma_f32_16x16x32_bf16 v[116:119], v[60:63], v[204:207], v[116:119]
    v_add_u32 v13, 0xfffea000, v13
    v_mfma_f32_16x16x32_bf16 v[120:123], v[64:67], v[140:143], v[120:123]
    ds_read_b64_tr_b16 v[40:41], v13 offset:0
    v_mfma_f32_16x16x32_bf16 v[124:127], v[64:67], v[204:207], v[124:127]
    ds_read_b64_tr_b16 v[42:43], v13 offset:6144
    s_barrier
    s_waitcnt lgkmcnt(0)
    v_mfma_f32_16x16x32_bf16 v[80:83], v[20:23], v[144:147], v[80:83]
    ds_read_b64_tr_b16 v[44:45], v8 offset:12288
    v_mfma_f32_16x16x32_bf16 v[84:87], v[20:23], v[208:211], v[84:87]
    ds_read_b64_tr_b16 v[46:47], v8 offset:18432
    v_mfma_f32_16x16x32_bf16 v[68:71], v[20:23], v[4:7], v[68:71]
    ds_read_b64_tr_b16 v[48:49], v9 offset:12288
    v_mfma_f32_16x16x32_bf16 v[88:91], v[24:27], v[144:147], v[88:91]
    ds_read_b64_tr_b16 v[50:51], v9 offset:18432
    v_mfma_f32_16x16x32_bf16 v[92:95], v[24:27], v[208:211], v[92:95]
    ds_read_b64_tr_b16 v[52:53], v10 offset:12288
    v_mfma_f32_16x16x32_bf16 v[72:75], v[24:27], v[4:7], v[72:75]
    ds_read_b64_tr_b16 v[54:55], v10 offset:18432
    v_mfma_f32_16x16x32_bf16 v[96:99], v[28:31], v[144:147], v[96:99]
    ds_read_b64_tr_b16 v[56:57], v11 offset:12288
    v_mfma_f32_16x16x32_bf16 v[100:103], v[28:31], v[208:211], v[100:103]
    ds_read_b64_tr_b16 v[58:59], v11 offset:18432
    v_mfma_f32_16x16x32_bf16 v[76:79], v[28:31], v[4:7], v[76:79]
    ds_read_b64_tr_b16 v[60:61], v12 offset:12288
    v_mfma_f32_16x16x32_bf16 v[104:107], v[32:35], v[144:147], v[104:107]
    ds_read_b64_tr_b16 v[62:63], v12 offset:18432
    v_mfma_f32_16x16x32_bf16 v[108:111], v[32:35], v[208:211], v[108:111]
    ds_read_b64_tr_b16 v[64:65], v13 offset:12288
    v_mfma_f32_16x16x32_bf16 v[112:115], v[36:39], v[144:147], v[112:115]
    ds_read_b64_tr_b16 v[66:67], v13 offset:18432
    v_mfma_f32_16x16x32_bf16 v[116:119], v[36:39], v[208:211], v[116:119]
    v_mfma_f32_16x16x32_bf16 v[120:123], v[40:43], v[144:147], v[120:123]
    v_mfma_f32_16x16x32_bf16 v[124:127], v[40:43], v[208:211], v[124:127]
    s_waitcnt lgkmcnt(0)
    v_mfma_f32_16x16x32_bf16 v[80:83], v[44:47], v[148:151], v[80:83]
    v_add_u32 v8, 0x6000, v8
    ds_read_b64_tr_b16 v[20:21], v8 offset:0
    v_mfma_f32_16x16x32_bf16 v[84:87], v[44:47], v[212:215], v[84:87]
    ds_read_b64_tr_b16 v[22:23], v8 offset:6144
    v_add_u32 v9, 0x6000, v9
    v_mfma_f32_16x16x32_bf16 v[68:71], v[44:47], v[4:7], v[68:71]
    ds_read_b64_tr_b16 v[24:25], v9 offset:0
    ds_read_b64_tr_b16 v[26:27], v9 offset:6144
    v_mfma_f32_16x16x32_bf16 v[88:91], v[48:51], v[148:151], v[88:91]
    v_add_u32 v10, 0x6000, v10
    v_mfma_f32_16x16x32_bf16 v[92:95], v[48:51], v[212:215], v[92:95]
    ds_read_b64_tr_b16 v[28:29], v10 offset:0
    v_mfma_f32_16x16x32_bf16 v[72:75], v[48:51], v[4:7], v[72:75]
    ds_read_b64_tr_b16 v[30:31], v10 offset:6144
    v_mfma_f32_16x16x32_bf16 v[96:99], v[52:55], v[148:151], v[96:99]
    v_add_u32 v11, 0x6000, v11
    v_mfma_f32_16x16x32_bf16 v[100:103], v[52:55], v[212:215], v[100:103]
    ds_read_b64_tr_b16 v[32:33], v11 offset:0
    v_mfma_f32_16x16x32_bf16 v[76:79], v[52:55], v[4:7], v[76:79]
    ds_read_b64_tr_b16 v[34:35], v11 offset:6144
    v_mfma_f32_16x16x32_bf16 v[104:107], v[56:59], v[148:151], v[104:107]
    v_add_u32 v12, 0x6000, v12
    v_mfma_f32_16x16x32_bf16 v[108:111], v[56:59], v[212:215], v[108:111]
    ds_read_b64_tr_b16 v[36:37], v12 offset:0
    v_mfma_f32_16x16x32_bf16 v[112:115], v[60:63], v[148:151], v[112:115]
    ds_read_b64_tr_b16 v[38:39], v12 offset:6144
    v_mfma_f32_16x16x32_bf16 v[116:119], v[60:63], v[212:215], v[116:119]
    v_add_u32 v13, 0x6000, v13
    v_mfma_f32_16x16x32_bf16 v[120:123], v[64:67], v[148:151], v[120:123]
    ds_read_b64_tr_b16 v[40:41], v13 offset:0
    v_mfma_f32_16x16x32_bf16 v[124:127], v[64:67], v[212:215], v[124:127]
    ds_read_b64_tr_b16 v[42:43], v13 offset:6144
    s_waitcnt vmcnt(0)
    s_barrier
    s_waitcnt lgkmcnt(0)
    v_mfma_f32_16x16x32_bf16 v[80:83], v[20:23], v[152:155], v[80:83]
    ds_read_b64_tr_b16 v[44:45], v8 offset:12288
    v_mfma_f32_16x16x32_bf16 v[84:87], v[20:23], v[216:219], v[84:87]
    ds_read_b64_tr_b16 v[46:47], v8 offset:18432
    v_mfma_f32_16x16x32_bf16 v[68:71], v[20:23], v[4:7], v[68:71]
    ds_read_b64_tr_b16 v[48:49], v9 offset:12288
    v_mfma_f32_16x16x32_bf16 v[88:91], v[24:27], v[152:155], v[88:91]
    ds_read_b64_tr_b16 v[50:51], v9 offset:18432
    v_mfma_f32_16x16x32_bf16 v[92:95], v[24:27], v[216:219], v[92:95]
    ds_read_b64_tr_b16 v[52:53], v10 offset:12288
    v_mfma_f32_16x16x32_bf16 v[72:75], v[24:27], v[4:7], v[72:75]
    ds_read_b64_tr_b16 v[54:55], v10 offset:18432
    v_mfma_f32_16x16x32_bf16 v[96:99], v[28:31], v[152:155], v[96:99]
    ds_read_b64_tr_b16 v[56:57], v11 offset:12288
    v_mfma_f32_16x16x32_bf16 v[100:103], v[28:31], v[216:219], v[100:103]
    ds_read_b64_tr_b16 v[58:59], v11 offset:18432
    v_mfma_f32_16x16x32_bf16 v[76:79], v[28:31], v[4:7], v[76:79]
    ds_read_b64_tr_b16 v[60:61], v12 offset:12288
    v_mfma_f32_16x16x32_bf16 v[104:107], v[32:35], v[152:155], v[104:107]
    ds_read_b64_tr_b16 v[62:63], v12 offset:18432
    v_mfma_f32_16x16x32_bf16 v[108:111], v[32:35], v[216:219], v[108:111]
    ds_read_b64_tr_b16 v[64:65], v13 offset:12288
    v_mfma_f32_16x16x32_bf16 v[112:115], v[36:39], v[152:155], v[112:115]
    ds_read_b64_tr_b16 v[66:67], v13 offset:18432
    v_mfma_f32_16x16x32_bf16 v[116:119], v[36:39], v[216:219], v[116:119]
    v_mfma_f32_16x16x32_bf16 v[120:123], v[40:43], v[152:155], v[120:123]
    v_mfma_f32_16x16x32_bf16 v[124:127], v[40:43], v[216:219], v[124:127]
    s_waitcnt lgkmcnt(0)
    v_mfma_f32_16x16x32_bf16 v[80:83], v[44:47], v[156:159], v[80:83]
    v_add_u32 v8, 0xa000, v8
    ds_read_b64_tr_b16 v[20:21], v8 offset:0
    v_mfma_f32_16x16x32_bf16 v[84:87], v[44:47], v[220:223], v[84:87]
    ds_read_b64_tr_b16 v[22:23], v8 offset:6144
    v_add_u32 v9, 0xa000, v9
    v_mfma_f32_16x16x32_bf16 v[68:71], v[44:47], v[4:7], v[68:71]
    ds_read_b64_tr_b16 v[24:25], v9 offset:0
    ds_read_b64_tr_b16 v[26:27], v9 offset:6144
    v_mfma_f32_16x16x32_bf16 v[88:91], v[48:51], v[156:159], v[88:91]
    v_add_u32 v10, 0xa000, v10
    v_mfma_f32_16x16x32_bf16 v[92:95], v[48:51], v[220:223], v[92:95]
    ds_read_b64_tr_b16 v[28:29], v10 offset:0
    v_mfma_f32_16x16x32_bf16 v[72:75], v[48:51], v[4:7], v[72:75]
    ds_read_b64_tr_b16 v[30:31], v10 offset:6144
    v_mfma_f32_16x16x32_bf16 v[96:99], v[52:55], v[156:159], v[96:99]
    v_add_u32 v11, 0xa000, v11
    v_mfma_f32_16x16x32_bf16 v[100:103], v[52:55], v[220:223], v[100:103]
    ds_read_b64_tr_b16 v[32:33], v11 offset:0
    v_mfma_f32_16x16x32_bf16 v[76:79], v[52:55], v[4:7], v[76:79]
    ds_read_b64_tr_b16 v[34:35], v11 offset:6144
    v_mfma_f32_16x16x32_bf16 v[104:107], v[56:59], v[156:159], v[104:107]
    v_add_u32 v12, 0xa000, v12
    v_mfma_f32_16x16x32_bf16 v[108:111], v[56:59], v[220:223], v[108:111]
    ds_read_b64_tr_b16 v[36:37], v12 offset:0
    v_mfma_f32_16x16x32_bf16 v[112:115], v[60:63], v[156:159], v[112:115]
    ds_read_b64_tr_b16 v[38:39], v12 offset:6144
    v_mfma_f32_16x16x32_bf16 v[116:119], v[60:63], v[220:223], v[116:119]
    v_add_u32 v13, 0xa000, v13
    v_mfma_f32_16x16x32_bf16 v[120:123], v[64:67], v[156:159], v[120:123]
    ds_read_b64_tr_b16 v[40:41], v13 offset:0
    v_mfma_f32_16x16x32_bf16 v[124:127], v[64:67], v[220:223], v[124:127]
    ds_read_b64_tr_b16 v[42:43], v13 offset:6144
    s_barrier
    s_waitcnt lgkmcnt(0)
    v_mfma_f32_16x16x32_bf16 v[80:83], v[20:23], v[160:163], v[80:83]
    ds_read_b64_tr_b16 v[44:45], v8 offset:12288
    v_mfma_f32_16x16x32_bf16 v[84:87], v[20:23], v[224:227], v[84:87]
    ds_read_b64_tr_b16 v[46:47], v8 offset:18432
    v_mfma_f32_16x16x32_bf16 v[68:71], v[20:23], v[4:7], v[68:71]
    ds_read_b64_tr_b16 v[48:49], v9 offset:12288
    v_mfma_f32_16x16x32_bf16 v[88:91], v[24:27], v[160:163], v[88:91]
    ds_read_b64_tr_b16 v[50:51], v9 offset:18432
    v_mfma_f32_16x16x32_bf16 v[92:95], v[24:27], v[224:227], v[92:95]
    ds_read_b64_tr_b16 v[52:53], v10 offset:12288
    v_mfma_f32_16x16x32_bf16 v[72:75], v[24:27], v[4:7], v[72:75]
    ds_read_b64_tr_b16 v[54:55], v10 offset:18432
    v_mfma_f32_16x16x32_bf16 v[96:99], v[28:31], v[160:163], v[96:99]
    ds_read_b64_tr_b16 v[56:57], v11 offset:12288
    v_mfma_f32_16x16x32_bf16 v[100:103], v[28:31], v[224:227], v[100:103]
    ds_read_b64_tr_b16 v[58:59], v11 offset:18432
    v_mfma_f32_16x16x32_bf16 v[76:79], v[28:31], v[4:7], v[76:79]
    ds_read_b64_tr_b16 v[60:61], v12 offset:12288
    v_mfma_f32_16x16x32_bf16 v[104:107], v[32:35], v[160:163], v[104:107]
    ds_read_b64_tr_b16 v[62:63], v12 offset:18432
    v_mfma_f32_16x16x32_bf16 v[108:111], v[32:35], v[224:227], v[108:111]
    ds_read_b64_tr_b16 v[64:65], v13 offset:12288
    v_mfma_f32_16x16x32_bf16 v[112:115], v[36:39], v[160:163], v[112:115]
    ds_read_b64_tr_b16 v[66:67], v13 offset:18432
    v_mfma_f32_16x16x32_bf16 v[116:119], v[36:39], v[224:227], v[116:119]
    v_mfma_f32_16x16x32_bf16 v[120:123], v[40:43], v[160:163], v[120:123]
    v_mfma_f32_16x16x32_bf16 v[124:127], v[40:43], v[224:227], v[124:127]
    s_waitcnt lgkmcnt(0)
    v_mfma_f32_16x16x32_bf16 v[80:83], v[44:47], v[164:167], v[80:83]
    v_add_u32 v8, 0x6000, v8
    ds_read_b64_tr_b16 v[20:21], v8 offset:0
    v_mfma_f32_16x16x32_bf16 v[84:87], v[44:47], v[228:231], v[84:87]
    ds_read_b64_tr_b16 v[22:23], v8 offset:6144
    v_add_u32 v9, 0x6000, v9
    v_mfma_f32_16x16x32_bf16 v[68:71], v[44:47], v[4:7], v[68:71]
    ds_read_b64_tr_b16 v[24:25], v9 offset:0
    ds_read_b64_tr_b16 v[26:27], v9 offset:6144
    v_mfma_f32_16x16x32_bf16 v[88:91], v[48:51], v[164:167], v[88:91]
    v_add_u32 v10, 0x6000, v10
    v_mfma_f32_16x16x32_bf16 v[92:95], v[48:51], v[228:231], v[92:95]
    ds_read_b64_tr_b16 v[28:29], v10 offset:0
    v_mfma_f32_16x16x32_bf16 v[72:75], v[48:51], v[4:7], v[72:75]
    ds_read_b64_tr_b16 v[30:31], v10 offset:6144
    v_mfma_f32_16x16x32_bf16 v[96:99], v[52:55], v[164:167], v[96:99]
    v_add_u32 v11, 0x6000, v11
    v_mfma_f32_16x16x32_bf16 v[100:103], v[52:55], v[228:231], v[100:103]
    ds_read_b64_tr_b16 v[32:33], v11 offset:0
    v_mfma_f32_16x16x32_bf16 v[76:79], v[52:55], v[4:7], v[76:79]
    ds_read_b64_tr_b16 v[34:35], v11 offset:6144
    v_mfma_f32_16x16x32_bf16 v[104:107], v[56:59], v[164:167], v[104:107]
    v_add_u32 v12, 0x6000, v12
    v_mfma_f32_16x16x32_bf16 v[108:111], v[56:59], v[228:231], v[108:111]
    ds_read_b64_tr_b16 v[36:37], v12 offset:0
    v_mfma_f32_16x16x32_bf16 v[112:115], v[60:63], v[164:167], v[112:115]
    ds_read_b64_tr_b16 v[38:39], v12 offset:6144
    v_mfma_f32_16x16x32_bf16 v[116:119], v[60:63], v[228:231], v[116:119]
    v_add_u32 v13, 0x6000, v13
    v_mfma_f32_16x16x32_bf16 v[120:123], v[64:67], v[164:167], v[120:123]
    ds_read_b64_tr_b16 v[40:41], v13 offset:0
    v_mfma_f32_16x16x32_bf16 v[124:127], v[64:67], v[228:231], v[124:127]
    ds_read_b64_tr_b16 v[42:43], v13 offset:6144
    s_waitcnt lgkmcnt(0)
    ds_read_b32 v1, v19 offset:152
    v_mfma_f32_16x16x32_bf16 v[80:83], v[20:23], v[168:171], v[80:83]
    ds_read_b64_tr_b16 v[44:45], v8 offset:12288
    v_mfma_f32_16x16x32_bf16 v[84:87], v[20:23], v[232:235], v[84:87]
    ds_read_b64_tr_b16 v[46:47], v8 offset:18432
    v_mfma_f32_16x16x32_bf16 v[68:71], v[20:23], v[4:7], v[68:71]
    ds_read_b64_tr_b16 v[48:49], v9 offset:12288
    v_mfma_f32_16x16x32_bf16 v[88:91], v[24:27], v[168:171], v[88:91]
    ds_read_b64_tr_b16 v[50:51], v9 offset:18432
    v_mfma_f32_16x16x32_bf16 v[92:95], v[24:27], v[232:235], v[92:95]
    ds_read_b64_tr_b16 v[52:53], v10 offset:12288
    v_mfma_f32_16x16x32_bf16 v[72:75], v[24:27], v[4:7], v[72:75]
    ds_read_b64_tr_b16 v[54:55], v10 offset:18432
    v_mfma_f32_16x16x32_bf16 v[96:99], v[28:31], v[168:171], v[96:99]
    ds_read_b64_tr_b16 v[56:57], v11 offset:12288
    v_mfma_f32_16x16x32_bf16 v[100:103], v[28:31], v[232:235], v[100:103]
    ds_read_b64_tr_b16 v[58:59], v11 offset:18432
    v_mfma_f32_16x16x32_bf16 v[76:79], v[28:31], v[4:7], v[76:79]
    ds_read_b64_tr_b16 v[60:61], v12 offset:12288
    s_waitcnt lgkmcnt(9)
    v_readfirstlane_b32 s66, v1
    s_nop 2
    s_cmp_ge_u32 s66, 4
    s_cbranch_scc1 Lsd_3
    s_mov_b32 s82, 4000000
Lsp_2:
    ds_read_b32 v1, v19 offset:152
    s_waitcnt lgkmcnt(0)
    v_readfirstlane_b32 s66, v1
    s_nop 2
    s_cmp_ge_u32 s66, 4
    s_cbranch_scc1 Lsd_3
    s_sub_u32 s82, s82, 1
    s_cmp_lg_u32 s82, 0
    s_cbranch_scc1 Lsp_2
Lsd_3:
    v_mfma_f32_16x16x32_bf16 v[104:107], v[32:35], v[168:171], v[104:107]
    ds_read_b64_tr_b16 v[62:63], v12 offset:18432
    v_mfma_f32_16x16x32_bf16 v[108:111], v[32:35], v[232:235], v[108:111]
    ds_read_b64_tr_b16 v[64:65], v13 offset:12288
    v_mfma_f32_16x16x32_bf16 v[112:115], v[36:39], v[168:171], v[112:115]
    ds_read_b64_tr_b16 v[66:67], v13 offset:18432
    v_mfma_f32_16x16x32_bf16 v[116:119], v[36:39], v[232:235], v[116:119]
    v_mfma_f32_16x16x32_bf16 v[120:123], v[40:43], v[168:171], v[120:123]
    v_mfma_f32_16x16x32_bf16 v[124:127], v[40:43], v[232:235], v[124:127]
    s_waitcnt lgkmcnt(0)
    s_mov_b64 exec, 1
    ds_add_u32 v19, v3 offset:180
    s_mov_b64 exec, -1
    v_mfma_f32_16x16x32_bf16 v[80:83], v[44:47], v[172:175], v[80:83]
    v_add_u32 v8, 0xfffea000, v8
    ds_read_b64_tr_b16 v[20:21], v8 offset:0
    v_mfma_f32_16x16x32_bf16 v[84:87], v[44:47], v[236:239], v[84:87]
    ds_read_b64_tr_b16 v[22:23], v8 offset:6144
    v_add_u32 v9, 0xfffea000, v9
    v_mfma_f32_16x16x32_bf16 v[68:71], v[44:47], v[4:7], v[68:71]
    ds_read_b64_tr_b16 v[24:25], v9 offset:0
    ds_read_b64_tr_b16 v[26:27], v9 offset:6144
    v_mfma_f32_16x16x32_bf16 v[88:91], v[48:51], v[172:175], v[88:91]
    v_add_u32 v10, 0xfffea000, v10
    v_mfma_f32_16x16x32_bf16 v[92:95], v[48:51], v[236:239], v[92:95]
    ds_read_b64_tr_b16 v[28:29], v10 offset:0
    v_mfma_f32_16x16x32_bf16 v[72:75], v[48:51], v[4:7], v[72:75]
    ds_read_b64_tr_b16 v[30:31], v10 offset:6144
    v_mfma_f32_16x16x32_bf16 v[96:99], v[52:55], v[172:175], v[96:99]
    v_add_u32 v11, 0xfffea000, v11
    v_mfma_f32_16x16x32_bf16 v[100:103], v[52:55], v[236:239], v[100:103]
    ds_read_b64_tr_b16 v[32:33], v11 offset:0
    v_mfma_f32_16x16x32_bf16 v[76:79], v[52:55], v[4:7], v[76:79]
    ds_read_b64_tr_b16 v[34:35], v11 offset:6144
    v_mfma_f32_16x16x32_bf16 v[104:107], v[56:59], v[172:175], v[104:107]
    v_add_u32 v12, 0xfffea000, v12
    v_mfma_f32_16x16x32_bf16 v[108:111], v[56:59], v[236:239], v[108:111]
    ds_read_b64_tr_b16 v[36:37], v12 offset:0
    v_mfma_f32_16x16x32_bf16 v[112:115], v[60:63], v[172:175], v[112:115]
    ds_read_b64_tr_b16 v[38:39], v12 offset:6144
    v_mfma_f32_16x16x32_bf16 v[116:119], v[60:63], v[236:239], v[116:119]
    v_add_u32 v13, 0xfffea000, v13
    v_mfma_f32_16x16x32_bf16 v[120:123], v[64:67], v[172:175], v[120:123]
    ds_read_b64_tr_b16 v[40:41], v13 offset:0
    v_mfma_f32_16x16x32_bf16 v[124:127], v[64:67], v[236:239], v[124:127]
    ds_read_b64_tr_b16 v[42:43], v13 offset:6144
    s_waitcnt lgkmcnt(0)
    ds_read_b32 v1, v19 offset:156
    v_mfma_f32_16x16x32_bf16 v[80:83], v[20:23], v[176:179], v[80:83]
    ds_read_b64_tr_b16 v[44:45], v8 offset:12288
    v_mfma_f32_16x16x32_bf16 v[84:87], v[20:23], v[240:243], v[84:87]
    ds_read_b64_tr_b16 v[46:47], v8 offset:18432
    v_mfma_f32_16x16x32_bf16 v[68:71], v[20:23], v[4:7], v[68:71]
    ds_read_b64_tr_b16 v[48:49], v9 offset:12288
    v_mfma_f32_16x16x32_bf16 v[88:91], v[24:27], v[176:179], v[88:91]
    ds_read_b64_tr_b16 v[50:51], v9 offset:18432
    v_mfma_f32_16x16x32_bf16 v[92:95], v[24:27], v[240:243], v[92:95]
    ds_read_b64_tr_b16 v[52:53], v10 offset:12288
    v_mfma_f32_16x16x32_bf16 v[72:75], v[24:27], v[4:7], v[72:75]
    ds_read_b64_tr_b16 v[54:55], v10 offset:18432
    v_mfma_f32_16x16x32_bf16 v[96:99], v[28:31], v[176:179], v[96:99]
    ds_read_b64_tr_b16 v[56:57], v11 offset:12288
    v_mfma_f32_16x16x32_bf16 v[100:103], v[28:31], v[240:243], v[100:103]
    ds_read_b64_tr_b16 v[58:59], v11 offset:18432
    v_mfma_f32_16x16x32_bf16 v[76:79], v[28:31], v[4:7], v[76:79]
    ds_read_b64_tr_b16 v[60:61], v12 offset:12288
    s_waitcnt lgkmcnt(9)
    v_readfirstlane_b32 s66, v1
    s_nop 2
    s_cmp_ge_u32 s66, 4
    s_cbranch_scc1 Lsd_5
    s_mov_b32 s82, 4000000
Lsp_4:
    ds_read_b32 v1, v19 offset:156
    s_waitcnt lgkmcnt(0)
    v_readfirstlane_b32 s66, v1
    s_nop 2
    s_cmp_ge_u32 s66, 4
    s_cbranch_scc1 Lsd_5
    s_sub_u32 s82, s82, 1
    s_cmp_lg_u32 s82, 0
    s_cbranch_scc1 Lsp_4
Lsd_5:
    v_mfma_f32_16x16x32_bf16 v[104:107], v[32:35], v[176:179], v[104:107]
    ds_read_b64_tr_b16 v[62:63], v12 offset:18432
    v_mfma_f32_16x16x32_bf16 v[108:111], v[32:35], v[240:243], v[108:111]
    ds_read_b64_tr_b16 v[64:65], v13 offset:12288
    v_mfma_f32_16x16x32_bf16 v[112:115], v[36:39], v[176:179], v[112:115]
    ds_read_b64_tr_b16 v[66:67], v13 offset:18432
    v_mfma_f32_16x16x32_bf16 v[116:119], v[36:39], v[240:243], v[116:119]
    v_mfma_f32_16x16x32_bf16 v[120:123], v[40:43], v[176:179], v[120:123]
    v_mfma_f32_16x16x32_bf16 v[124:127], v[40:43], v[240:243], v[124:127]
    s_waitcnt lgkmcnt(0)
    v_mfma_f32_16x16x32_bf16 v[80:83], v[44:47], v[180:183], v[80:83]
    v_add_u32 v8, 0x6000, v8
    ds_read_b64_tr_b16 v[20:21], v8 offset:0
    v_mfma_f32_16x16x32_bf16 v[84:87], v[44:47], v[244:247], v[84:87]
    ds_read_b64_tr_b16 v[22:23], v8 offset:6144
    v_add_u32 v9, 0x6000, v9
    v_mfma_f32_16x16x32_bf16 v[68:71], v[44:47], v[4:7], v[68:71]
    ds_read_b64_tr_b16 v[24:25], v9 offset:0
    ds_read_b64_tr_b16 v[26:27], v9 offset:6144
    v_mfma_f32_16x16x32_bf16 v[88:91], v[48:51], v[180:183], v[88:91]
    v_add_u32 v10, 0x6000, v10
    v_mfma_f32_16x16x32_bf16 v[92:95], v[48:51], v[244:247], v[92:95]
    ds_read_b64_tr_b16 v[28:29], v10 offset:0
    v_mfma_f32_16x16x32_bf16 v[72:75], v[48:51], v[4:7], v[72:75]
    ds_read_b64_tr_b16 v[30:31], v10 offset:6144
    v_mfma_f32_16x16x32_bf16 v[96:99], v[52:55], v[180:183], v[96:99]
    v_add_u32 v11, 0x6000, v11
    v_mfma_f32_16x16x32_bf16 v[100:103], v[52:55], v[244:247], v[100:103]
    ds_read_b64_tr_b16 v[32:33], v11 offset:0
    v_mfma_f32_16x16x32_bf16 v[76:79], v[52:55], v[4:7], v[76:79]
    ds_read_b64_tr_b16 v[34:35], v11 offset:6144
    v_mfma_f32_16x16x32_bf16 v[104:107], v[56:59], v[180:183], v[104:107]
    v_add_u32 v12, 0x6000, v12
    v_mfma_f32_16x16x32_bf16 v[108:111], v[56:59], v[244:247], v[108:111]
    ds_read_b64_tr_b16 v[36:37], v12 offset:0
    v_mfma_f32_16x16x32_bf16 v[112:115], v[60:63], v[180:183], v[112:115]
    ds_read_b64_tr_b16 v[38:39], v12 offset:6144
    v_mfma_f32_16x16x32_bf16 v[116:119], v[60:63], v[244:247], v[116:119]
    v_add_u32 v13, 0x6000, v13
    v_mfma_f32_16x16x32_bf16 v[120:123], v[64:67], v[180:183], v[120:123]
    ds_read_b64_tr_b16 v[40:41], v13 offset:0
    v_mfma_f32_16x16x32_bf16 v[124:127], v[64:67], v[244:247], v[124:127]
    ds_read_b64_tr_b16 v[42:43], v13 offset:6144
    s_waitcnt lgkmcnt(0)
    v_mfma_f32_16x16x32_bf16 v[80:83], v[20:23], v[184:187], v[80:83]
    ds_read_b64_tr_b16 v[44:45], v8 offset:12288
    v_mfma_f32_16x16x32_bf16 v[84:87], v[20:23], v[248:251], v[84:87]
    ds_read_b64_tr_b16 v[46:47], v8 offset:18432
    v_mfma_f32_16x16x32_bf16 v[68:71], v[20:23], v[4:7], v[68:71]
    ds_read_b64_tr_b16 v[48:49], v9 offset:12288
    v_mfma_f32_16x16x32_bf16 v[88:91], v[24:27], v[184:187], v[88:91]
    ds_read_b64_tr_b16 v[50:51], v9 offset:18432
    v_mfma_f32_16x16x32_bf16 v[92:95], v[24:27], v[248:251], v[92:95]
    ds_read_b64_tr_b16 v[52:53], v10 offset:12288
    v_mfma_f32_16x16x32_bf16 v[72:75], v[24:27], v[4:7], v[72:75]
    ds_read_b64_tr_b16 v[54:55], v10 offset:18432
    v_mfma_f32_16x16x32_bf16 v[96:99], v[28:31], v[184:187], v[96:99]
    ds_read_b64_tr_b16 v[56:57], v11 offset:12288
    v_mfma_f32_16x16x32_bf16 v[100:103], v[28:31], v[248:251], v[100:103]
    ds_read_b64_tr_b16 v[58:59], v11 offset:18432
    v_mfma_f32_16x16x32_bf16 v[76:79], v[28:31], v[4:7], v[76:79]
    ds_read_b64_tr_b16 v[60:61], v12 offset:12288
    v_mfma_f32_16x16x32_bf16 v[104:107], v[32:35], v[184:187], v[104:107]
    ds_read_b64_tr_b16 v[62:63], v12 offset:18432
    v_mfma_f32_16x16x32_bf16 v[108:111], v[32:35], v[248:251], v[108:111]
    ds_read_b64_tr_b16 v[64:65], v13 offset:12288
    v_mfma_f32_16x16x32_bf16 v[112:115], v[36:39], v[184:187], v[112:115]
    ds_read_b64_tr_b16 v[66:67], v13 offset:18432
    v_mfma_f32_16x16x32_bf16 v[116:119], v[36:39], v[248:251], v[116:119]
    v_mfma_f32_16x16x32_bf16 v[120:123], v[40:43], v[184:187], v[120:123]
    v_mfma_f32_16x16x32_bf16 v[124:127], v[40:43], v[248:251], v[124:127]
    s_waitcnt lgkmcnt(0)
    v_mfma_f32_16x16x32_bf16 v[80:83], v[44:47], v[188:191], v[80:83]
    v_mfma_f32_16x16x32_bf16 v[84:87], v[44:47], v[252:255], v[84:87]
    v_mfma_f32_16x16x32_bf16 v[68:71], v[44:47], v[4:7], v[68:71]
    v_mfma_f32_16x16x32_bf16 v[88:91], v[48:51], v[188:191], v[88:91]
    v_mfma_f32_16x16x32_bf16 v[92:95], v[48:51], v[252:255], v[92:95]
    v_mfma_f32_16x16x32_bf16 v[72:75], v[48:51], v[4:7], v[72:75]
    v_mfma_f32_16x16x32_bf16 v[96:99], v[52:55], v[188:191], v[96:99]
    v_mfma_f32_16x16x32_bf16 v[100:103], v[52:55], v[252:255], v[100:103]
    v_mfma_f32_16x16x32_bf16 v[76:79], v[52:55], v[4:7], v[76:79]
    v_mfma_f32_16x16x32_bf16 v[104:107], v[56:59], v[188:191], v[104:107]
    v_mfma_f32_16x16x32_bf16 v[108:111], v[56:59], v[252:255], v[108:111]
    v_mfma_f32_16x16x32_bf16 v[112:115], v[60:63], v[188:191], v[112:115]
    v_mfma_f32_16x16x32_bf16 v[116:119], v[60:63], v[252:255], v[116:119]
    v_mfma_f32_16x16x32_bf16 v[120:123], v[64:67], v[188:191], v[120:123]
    v_mfma_f32_16x16x32_bf16 v[124:127], v[64:67], v[252:255], v[124:127]
    v_lshrrev_b32 v1, 4, v0
    v_lshlrev_b32 v1, 4, v1
    s_mul_i32 s62, s58, 384
    s_add_u32 s62, s62, 150528
    v_add_u32 v1, s62, v1
    v_and_b32 v2, 15, v0
    v_cmp_eq_u32 vcc, 0, v2
    s_nop 2
    s_and_saveexec_b64 s[74:75], vcc
    ds_write_b128 v1, v[68:71] offset:0
    ds_write_b128 v1, v[72:75] offset:64
    ds_write_b128 v1, v[76:79] offset:128
    s_mov_b64 exec, s[74:75]
    s_waitcnt lgkmcnt(0)
    s_branch L_gdone
L_gl1:
    s_barrier
    s_waitcnt lgkmcnt(0)
    v_mfma_f32_16x16x32_bf16 v[80:83], v[20:23], v[128:131], 0
    ds_read_b64_tr_b16 v[44:45], v8 offset:12288
    v_mfma_f32_16x16x32_bf16 v[84:87], v[20:23], v[192:195], 0
    ds_read_b64_tr_b16 v[46:47], v8 offset:18432
    v_mfma_f32_16x16x32_bf16 v[88:91], v[24:27], v[128:131], 0
    ds_read_b64_tr_b16 v[48:49], v9 offset:12288
    v_mfma_f32_16x16x32_bf16 v[92:95], v[24:27], v[192:195], 0
    ds_read_b64_tr_b16 v[50:51], v9 offset:18432
    v_mfma_f32_16x16x32_bf16 v[96:99], v[28:31], v[128:131], 0
    ds_read_b64_tr_b16 v[52:53], v10 offset:12288
    v_mfma_f32_16x16x32_bf16 v[100:103], v[28:31], v[192:195], 0
    ds_read_b64_tr_b16 v[54:55], v10 offset:18432
    v_mfma_f32_16x16x32_bf16 v[104:107], v[32:35], v[128:131], 0
    ds_read_b64_tr_b16 v[56:57], v11 offset:12288
    v_mfma_f32_16x16x32_bf16 v[108:111], v[32:35], v[192:195], 0
    ds_read_b64_tr_b16 v[58:59], v11 offset:18432
    v_mfma_f32_16x16x32_bf16 v[68:71], v[32:35], v[4:7], 0
    ds_read_b64_tr_b16 v[60:61], v12 offset:12288
    v_mfma_f32_16x16x32_bf16 v[112:115], v[36:39], v[128:131], 0
    ds_read_b64_tr_b16 v[62:63], v12 offset:18432
    v_mfma_f32_16x16x32_bf16 v[116:119], v[36:39], v[192:195], 0
    ds_read_b64_tr_b16 v[64:65], v13 offset:12288
    v_mfma_f32_16x16x32_bf16 v[72:75], v[36:39], v[4:7], 0
    ds_read_b64_tr_b16 v[66:67], v13 offset:18432
    v_mfma_f32_16x16x32_bf16 v[120:123], v[40:43], v[128:131], 0
    v_mfma_f32_16x16x32_bf16 v[124:127], v[40:43], v[192:195], 0
    v_mfma_f32_16x16x32_bf16 v[76:79], v[40:43], v[4:7], 0
    s_waitcnt lgkmcnt(0)
    v_mfma_f32_16x16x32_bf16 v[80:83], v[44:47], v[132:135], v[80:83]
    v_add_u32 v8, 0x6000, v8
    ds_read_b64_tr_b16 v[20:21], v8 offset:0
    v_mfma_f32_16x16x32_bf16 v[84:87], v[44:47], v[196:199], v[84:87]
    ds_read_b64_tr_b16 v[22:23], v8 offset:6144
    v_add_u32 v9, 0x6000, v9
    v_mfma_f32_16x16x32_bf16 v[88:91], v[48:51], v[132:135], v[88:91]
    ds_read_b64_tr_b16 v[24:25], v9 offset:0
    ds_read_b64_tr_b16 v[26:27], v9 offset:6144
    v_mfma_f32_16x16x32_bf16 v[92:95], v[48:51], v[196:199], v[92:95]
    v_add_u32 v10, 0x6000, v10
    v_mfma_f32_16x16x32_bf16 v[96:99], v[52:55], v[132:135], v[96:99]
    ds_read_b64_tr_b16 v[28:29], v10 offset:0
    v_mfma_f32_16x16x32_bf16 v[100:103], v[52:55], v[196:199], v[100:103]
    ds_read_b64_tr_b16 v[30:31], v10 offset:6144
    v_mfma_f32_16x16x32_bf16 v[104:107], v[56:59], v[132:135], v[104:107]
    v_add_u32 v11, 0x6000, v11
    v_mfma_f32_16x16x32_bf16 v[108:111], v[56:59], v[196:199], v[108:111]
    ds_read_b64_tr_b16 v[32:33], v11 offset:0
    v_mfma_f32_16x16x32_bf16 v[68:71], v[56:59], v[4:7], v[68:71]
    ds_read_b64_tr_b16 v[34:35], v11 offset:6144
    v_mfma_f32_16x16x32_bf16 v[112:115], v[60:63], v[132:135], v[112:115]
    v_add_u32 v12, 0x6000, v12
    v_mfma_f32_16x16x32_bf16 v[116:119], v[60:63], v[196:199], v[116:119]
    ds_read_b64_tr_b16 v[36:37], v12 offset:0
    v_mfma_f32_16x16x32_bf16 v[72:75], v[60:63], v[4:7], v[72:75]
    ds_read_b64_tr_b16 v[38:39], v12 offset:6144
    v_mfma_f32_16x16x32_bf16 v[120:123], v[64:67], v[132:135], v[120:123]
    v_add_u32 v13, 0x6000, v13
    v_mfma_f32_16x16x32_bf16 v[124:127], v[64:67], v[196:199], v[124:127]
    ds_read_b64_tr_b16 v[40:41], v13 offset:0
    v_mfma_f32_16x16x32_bf16 v[76:79], v[64:67], v[4:7], v[76:79]
    ds_read_b64_tr_b16 v[42:43], v13 offset:6144
    s_barrier
    s_waitcnt lgkmcnt(0)
    v_mfma_f32_16x16x32_bf16 v[80:83], v[20:23], v[136:139], v[80:83]
    ds_read_b64_tr_b16 v[44:45], v8 offset:12288
    v_mfma_f32_16x16x32_bf16 v[84:87], v[20:23], v[200:203], v[84:87]
    ds_read_b64_tr_b16 v[46:47], v8 offset:18432
    v_mfma_f32_16x16x32_bf16 v[88:91], v[24:27], v[136:139], v[88:91]
    ds_read_b64_tr_b16 v[48:49], v9 offset:12288
    v_mfma_f32_16x16x32_bf16 v[92:95], v[24:27], v[200:203], v[92:95]
    ds_read_b64_tr_b16 v[50:51], v9 offset:18432
    v_mfma_f32_16x16x32_bf16 v[96:99], v[28:31], v[136:139], v[96:99]
    ds_read_b64_tr_b16 v[52:53], v10 offset:12288
    v_mfma_f32_16x16x32_bf16 v[100:103], v[28:31], v[200:203], v[100:103]
    ds_read_b64_tr_b16 v[54:55], v10 offset:18432
    v_mfma_f32_16x16x32_bf16 v[104:107], v[32:35], v[136:139], v[104:107]
    ds_read_b64_tr_b16 v[56:57], v11 offset:12288
    v_mfma_f32_16x16x32_bf16 v[108:111], v[32:35], v[200:203], v[108:111]
    ds_read_b64_tr_b16 v[58:59], v11 offset:18432
    v_mfma_f32_16x16x32_bf16 v[68:71], v[32:35], v[4:7], v[68:71]
    ds_read_b64_tr_b16 v[60:61], v12 offset:12288
    v_mfma_f32_16x16x32_bf16 v[112:115], v[36:39], v[136:139], v[112:115]
    ds_read_b64_tr_b16 v[62:63], v12 offset:18432
    v_mfma_f32_16x16x32_bf16 v[116:119], v[36:39], v[200:203], v[116:119]
    ds_read_b64_tr_b16 v[64:65], v13 offset:12288
    v_mfma_f32_16x16x32_bf16 v[72:75], v[36:39], v[4:7], v[72:75]
    ds_read_b64_tr_b16 v[66:67], v13 offset:18432
    v_mfma_f32_16x16x32_bf16 v[120:123], v[40:43], v[136:139], v[120:123]
    v_mfma_f32_16x16x32_bf16 v[124:127], v[40:43], v[200:203], v[124:127]
    v_mfma_f32_16x16x32_bf16 v[76:79], v[40:43], v[4:7], v[76:79]
    s_waitcnt lgkmcnt(0)
    v_mfma_f32_16x16x32_bf16 v[80:83], v[44:47], v[140:143], v[80:83]
    v_add_u32 v8, 0xfffea000, v8
    ds_read_b64_tr_b16 v[20:21], v8 offset:0
    v_mfma_f32_16x16x32_bf16 v[84:87], v[44:47], v[204:207], v[84:87]
    ds_read_b64_tr_b16 v[22:23], v8 offset:6144
    v_add_u32 v9, 0xfffea000, v9
    v_mfma_f32_16x16x32_bf16 v[88:91], v[48:51], v[140:143], v[88:91]
    ds_read_b64_tr_b16 v[24:25], v9 offset:0
    ds_read_b64_tr_b16 v[26:27], v9 offset:6144
    v_mfma_f32_16x16x32_bf16 v[92:95], v[48:51], v[204:207], v[92:95]
    v_add_u32 v10, 0xfffea000, v10
    v_mfma_f32_16x16x32_bf16 v[96:99], v[52:55], v[140:143], v[96:99]
    ds_read_b64_tr_b16 v[28:29], v10 offset:0
    v_mfma_f32_16x16x32_bf16 v[100:103], v[52:55], v[204:207], v[100:103]
    ds_read_b64_tr_b16 v[30:31], v10 offset:6144
    v_mfma_f32_16x16x32_bf16 v[104:107], v[56:59], v[140:143], v[104:107]
    v_add_u32 v11, 0xfffea000, v11
    v_mfma_f32_16x16x32_bf16 v[108:111], v[56:59], v[204:207], v[108:111]
    ds_read_b64_tr_b16 v[32:33], v11 offset:0
    v_mfma_f32_16x16x32_bf16 v[68:71], v[56:59], v[4:7], v[68:71]
    ds_read_b64_tr_b16 v[34:35], v11 offset:6144
    v_mfma_f32_16x16x32_bf16 v[112:115], v[60:63], v[140:143], v[112:115]
    v_add_u32 v12, 0xfffea000, v12
    v_mfma_f32_16x16x32_bf16 v[116:119], v[60:63], v[204:207], v[116:119]
    ds_read_b64_tr_b16 v[36:37], v12 offset:0
    v_mfma_f32_16x16x32_bf16 v[72:75], v[60:63], v[4:7], v[72:75]
    ds_read_b64_tr_b16 v[38:39], v12 offset:6144
    v_mfma_f32_16x16x32_bf16 v[120:123], v[64:67], v[140:143], v[120:123]
    v_add_u32 v13, 0xfffea000, v13
    v_mfma_f32_16x16x32_bf16 v[124:127], v[64:67], v[204:207], v[124:127]
    ds_read_b64_tr_b16 v[40:41], v13 offset:0
    v_mfma_f32_16x16x32_bf16 v[76:79], v[64:67], v[4:7], v[76:79]
    ds_read_b64_tr_b16 v[42:43], v13 offset:6144
    s_barrier
    s_waitcnt lgkmcnt(0)
    v_mfma_f32_16x16x32_bf16 v[80:83], v[20:23], v[144:147], v[80:83]
    ds_read_b64_tr_b16 v[44:45], v8 offset:12288
    v_mfma_f32_16x16x32_bf16 v[84:87], v[20:23], v[208:211], v[84:87]
    ds_read_b64_tr_b16 v[46:47], v8 offset:18432
    v_mfma_f32_16x16x32_bf16 v[88:91], v[24:27], v[144:147], v[88:91]
    ds_read_b64_tr_b16 v[48:49], v9 offset:12288
    v_mfma_f32_16x16x32_bf16 v[92:95], v[24:27], v[208:211], v[92:95]
    ds_read_b64_tr_b16 v[50:51], v9 offset:18432
    v_mfma_f32_16x16x32_bf16 v[96:99], v[28:31], v[144:147], v[96:99]
    ds_read_b64_tr_b16 v[52:53], v10 offset:12288
    v_mfma_f32_16x16x32_bf16 v[100:103], v[28:31], v[208:211], v[100:103]
    ds_read_b64_tr_b16 v[54:55], v10 offset:18432
    v_mfma_f32_16x16x32_bf16 v[104:107], v[32:35], v[144:147], v[104:107]
    ds_read_b64_tr_b16 v[56:57], v11 offset:12288
    v_mfma_f32_16x16x32_bf16 v[108:111], v[32:35], v[208:211], v[108:111]
    ds_read_b64_tr_b16 v[58:59], v11 offset:18432
    v_mfma_f32_16x16x32_bf16 v[68:71], v[32:35], v[4:7], v[68:71]
    ds_read_b64_tr_b16 v[60:61], v12 offset:12288
    v_mfma_f32_16x16x32_bf16 v[112:115], v[36:39], v[144:147], v[112:115]
    ds_read_b64_tr_b16 v[62:63], v12 offset:18432
    v_mfma_f32_16x16x32_bf16 v[116:119], v[36:39], v[208:211], v[116:119]
    ds_read_b64_tr_b16 v[64:65], v13 offset:12288
    v_mfma_f32_16x16x32_bf16 v[72:75], v[36:39], v[4:7], v[72:75]
    ds_read_b64_tr_b16 v[66:67], v13 offset:18432
    v_mfma_f32_16x16x32_bf16 v[120:123], v[40:43], v[144:147], v[120:123]
    v_mfma_f32_16x16x32_bf16 v[124:127], v[40:43], v[208:211], v[124:127]
    v_mfma_f32_16x16x32_bf16 v[76:79], v[40:43], v[4:7], v[76:79]
    s_waitcnt lgkmcnt(0)
    v_mfma_f32_16x16x32_bf16 v[80:83], v[44:47], v[148:151], v[80:83]
    v_add_u32 v8, 0x6000, v8
    ds_read_b64_tr_b16 v[20:21], v8 offset:0
    v_mfma_f32_16x16x32_bf16 v[84:87], v[44:47], v[212:215], v[84:87]
    ds_read_b64_tr_b16 v[22:23], v8 offset:6144
    v_add_u32 v9, 0x6000, v9
    v_mfma_f32_16x16x32_bf16 v[88:91], v[48:51], v[148:151], v[88:91]
    ds_read_b64_tr_b16 v[24:25], v9 offset:0
    ds_read_b64_tr_b16 v[26:27], v9 offset:6144
    v_mfma_f32_16x16x32_bf16 v[92:95], v[48:51], v[212:215], v[92:95]
    v_add_u32 v10, 0x6000, v10
    v_mfma_f32_16x16x32_bf16 v[96:99], v[52:55], v[148:151], v[96:99]
    ds_read_b64_tr_b16 v[28:29], v10 offset:0
    v_mfma_f32_16x16x32_bf16 v[100:103], v[52:55], v[212:215], v[100:103]
    ds_read_b64_tr_b16 v[30:31], v10 offset:6144
    v_mfma_f32_16x16x32_bf16 v[104:107], v[56:59], v[148:151], v[104:107]
    v_add_u32 v11, 0x6000, v11
    v_mfma_f32_16x16x32_bf16 v[108:111], v[56:59], v[212:215], v[108:111]
    ds_read_b64_tr_b16 v[32:33], v11 offset:0
    v_mfma_f32_16x16x32_bf16 v[68:71], v[56:59], v[4:7], v[68:71]
    ds_read_b64_tr_b16 v[34:35], v11 offset:6144
    v_mfma_f32_16x16x32_bf16 v[112:115], v[60:63], v[148:151], v[112:115]
    v_add_u32 v12, 0x6000, v12
    v_mfma_f32_16x16x32_bf16 v[116:119], v[60:63], v[212:215], v[116:119]
    ds_read_b64_tr_b16 v[36:37], v12 offset:0
    v_mfma_f32_16x16x32_bf16 v[72:75], v[60:63], v[4:7], v[72:75]
    ds_read_b64_tr_b16 v[38:39], v12 offset:6144
    v_mfma_f32_16x16x32_bf16 v[120:123], v[64:67], v[148:151], v[120:123]
    v_add_u32 v13, 0x6000, v13
    v_mfma_f32_16x16x32_bf16 v[124:127], v[64:67], v[212:215], v[124:127]
    ds_read_b64_tr_b16 v[40:41], v13 offset:0
    v_mfma_f32_16x16x32_bf16 v[76:79], v[64:67], v[4:7], v[76:79]
    ds_read_b64_tr_b16 v[42:43], v13 offset:6144
    s_waitcnt vmcnt(0)
    s_barrier
    s_waitcnt lgkmcnt(0)
    v_mfma_f32_16x16x32_bf16 v[80:83], v[20:23], v[152:155], v[80:83]
    ds_read_b64_tr_b16 v[44:45], v8 offset:12288
    v_mfma_f32_16x16x32_bf16 v[84:87], v[20:23], v[216:219], v[84:87]
    ds_read_b64_tr_b16 v[46:47], v8 offset:18432
    v_mfma_f32_16x16x32_bf16 v[88:91], v[24:27], v[152:155], v[88:91]
    ds_read_b64_tr_b16 v[48:49], v9 offset:12288
    v_mfma_f32_16x16x32_bf16 v[92:95], v[24:27], v[216:219], v[92:95]
    ds_read_b64_tr_b16 v[50:51], v9 offset:18432
    v_mfma_f32_16x16x32_bf16 v[96:99], v[28:31], v[152:155], v[96:99]
    ds_read_b64_tr_b16 v[52:53], v10 offset:12288
    v_mfma_f32_16x16x32_bf16 v[100:103], v[28:31], v[216:219], v[100:103]
    ds_read_b64_tr_b16 v[54:55], v10 offset:18432
    v_mfma_f32_16x16x32_bf16 v[104:107], v[32:35], v[152:155], v[104:107]
    ds_read_b64_tr_b16 v[56:57], v11 offset:12288
    v_mfma_f32_16x16x32_bf16 v[108:111], v[32:35], v[216:219], v[108:111]
    ds_read_b64_tr_b16 v[58:59], v11 offset:18432
    v_mfma_f32_16x16x32_bf16 v[68:71], v[32:35], v[4:7], v[68:71]
    ds_read_b64_tr_b16 v[60:61], v12 offset:12288
    v_mfma_f32_16x16x32_bf16 v[112:115], v[36:39], v[152:155], v[112:115]
    ds_read_b64_tr_b16 v[62:63], v12 offset:18432
    v_mfma_f32_16x16x32_bf16 v[116:119], v[36:39], v[216:219], v[116:119]
    ds_read_b64_tr_b16 v[64:65], v13 offset:12288
    v_mfma_f32_16x16x32_bf16 v[72:75], v[36:39], v[4:7], v[72:75]
    ds_read_b64_tr_b16 v[66:67], v13 offset:18432
    v_mfma_f32_16x16x32_bf16 v[120:123], v[40:43], v[152:155], v[120:123]
    v_mfma_f32_16x16x32_bf16 v[124:127], v[40:43], v[216:219], v[124:127]
    v_mfma_f32_16x16x32_bf16 v[76:79], v[40:43], v[4:7], v[76:79]
    s_waitcnt lgkmcnt(0)
    v_mfma_f32_16x16x32_bf16 v[80:83], v[44:47], v[156:159], v[80:83]
    v_add_u32 v8, 0xa000, v8
    ds_read_b64_tr_b16 v[20:21], v8 offset:0
    v_mfma_f32_16x16x32_bf16 v[84:87], v[44:47], v[220:223], v[84:87]
    ds_read_b64_tr_b16 v[22:23], v8 offset:6144
    v_add_u32 v9, 0xa000, v9
    v_mfma_f32_16x16x32_bf16 v[88:91], v[48:51], v[156:159], v[88:91]
    ds_read_b64_tr_b16 v[24:25], v9 offset:0
    ds_read_b64_tr_b16 v[26:27], v9 offset:6144
    v_mfma_f32_16x16x32_bf16 v[92:95], v[48:51], v[220:223], v[92:95]
    v_add_u32 v10, 0xa000, v10
    v_mfma_f32_16x16x32_bf16 v[96:99], v[52:55], v[156:159], v[96:99]
    ds_read_b64_tr_b16 v[28:29], v10 offset:0
    v_mfma_f32_16x16x32_bf16 v[100:103], v[52:55], v[220:223], v[100:103]
    ds_read_b64_tr_b16 v[30:31], v10 offset:6144
    v_mfma_f32_16x16x32_bf16 v[104:107], v[56:59], v[156:159], v[104:107]
    v_add_u32 v11, 0xa000, v11
    v_mfma_f32_16x16x32_bf16 v[108:111], v[56:59], v[220:223], v[108:111]
    ds_read_b64_tr_b16 v[32:33], v11 offset:0
    v_mfma_f32_16x16x32_bf16 v[68:71], v[56:59], v[4:7], v[68:71]
    ds_read_b64_tr_b16 v[34:35], v11 offset:6144
    v_mfma_f32_16x16x32_bf16 v[112:115], v[60:63], v[156:159], v[112:115]
    v_add_u32 v12, 0xa000, v12
    v_mfma_f32_16x16x32_bf16 v[116:119], v[60:63], v[220:223], v[116:119]
    ds_read_b64_tr_b16 v[36:37], v12 offset:0
    v_mfma_f32_16x16x32_bf16 v[72:75], v[60:63], v[4:7], v[72:75]
    ds_read_b64_tr_b16 v[38:39], v12 offset:6144
    v_mfma_f32_16x16x32_bf16 v[120:123], v[64:67], v[156:159], v[120:123]
    v_add_u32 v13, 0xa000, v13
    v_mfma_f32_16x16x32_bf16 v[124:127], v[64:67], v[220:223], v[124:127]
    ds_read_b64_tr_b16 v[40:41], v13 offset:0
    v_mfma_f32_16x16x32_bf16 v[76:79], v[64:67], v[4:7], v[76:79]
    ds_read_b64_tr_b16 v[42:43], v13 offset:6144
    s_barrier
    s_waitcnt lgkmcnt(0)
    v_mfma_f32_16x16x32_bf16 v[80:83], v[20:23], v[160:163], v[80:83]
    ds_read_b64_tr_b16 v[44:45], v8 offset:12288
    v_mfma_f32_16x16x32_bf16 v[84:87], v[20:23], v[224:227], v[84:87]
    ds_read_b64_tr_b16 v[46:47], v8 offset:18432
    v_mfma_f32_16x16x32_bf16 v[88:91], v[24:27], v[160:163], v[88:91]
    ds_read_b64_tr_b16 v[48:49], v9 offset:12288
    v_mfma_f32_16x16x32_bf16 v[92:95], v[24:27], v[224:227], v[92:95]
    ds_read_b64_tr_b16 v[50:51], v9 offset:18432
    v_mfma_f32_16x16x32_bf16 v[96:99], v[28:31], v[160:163], v[96:99]
    ds_read_b64_tr_b16 v[52:53], v10 offset:12288
    v_mfma_f32_16x16x32_bf16 v[100:103], v[28:31], v[224:227], v[100:103]
    ds_read_b64_tr_b16 v[54:55], v10 offset:18432
    v_mfma_f32_16x16x32_bf16 v[104:107], v[32:35], v[160:163], v[104:107]
    ds_read_b64_tr_b16 v[56:57], v11 offset:12288
    v_mfma_f32_16x16x32_bf16 v[108:111], v[32:35], v[224:227], v[108:111]
    ds_read_b64_tr_b16 v[58:59], v11 offset:18432
    v_mfma_f32_16x16x32_bf16 v[68:71], v[32:35], v[4:7], v[68:71]
    ds_read_b64_tr_b16 v[60:61], v12 offset:12288
    v_mfma_f32_16x16x32_bf16 v[112:115], v[36:39], v[160:163], v[112:115]
    ds_read_b64_tr_b16 v[62:63], v12 offset:18432
    v_mfma_f32_16x16x32_bf16 v[116:119], v[36:39], v[224:227], v[116:119]
    ds_read_b64_tr_b16 v[64:65], v13 offset:12288
    v_mfma_f32_16x16x32_bf16 v[72:75], v[36:39], v[4:7], v[72:75]
    ds_read_b64_tr_b16 v[66:67], v13 offset:18432
    v_mfma_f32_16x16x32_bf16 v[120:123], v[40:43], v[160:163], v[120:123]
    v_mfma_f32_16x16x32_bf16 v[124:127], v[40:43], v[224:227], v[124:127]
    v_mfma_f32_16x16x32_bf16 v[76:79], v[40:43], v[4:7], v[76:79]
    s_waitcnt lgkmcnt(0)
    v_mfma_f32_16x16x32_bf16 v[80:83], v[44:47], v[164:167], v[80:83]
    v_add_u32 v8, 0x6000, v8
    ds_read_b64_tr_b16 v[20:21], v8 offset:0
    v_mfma_f32_16x16x32_bf16 v[84:87], v[44:47], v[228:231], v[84:87]
    ds_read_b64_tr_b16 v[22:23], v8 offset:6144
    v_add_u32 v9, 0x6000, v9
    v_mfma_f32_16x16x32_bf16 v[88:91], v[48:51], v[164:167], v[88:91]
    ds_read_b64_tr_b16 v[24:25], v9 offset:0
    ds_read_b64_tr_b16 v[26:27], v9 offset:6144
    v_mfma_f32_16x16x32_bf16 v[92:95], v[48:51], v[228:231], v[92:95]
    v_add_u32 v10, 0x6000, v10
    v_mfma_f32_16x16x32_bf16 v[96:99], v[52:55], v[164:167], v[96:99]
    ds_read_b64_tr_b16 v[28:29], v10 offset:0
    v_mfma_f32_16x16x32_bf16 v[100:103], v[52:55], v[228:231], v[100:103]
    ds_read_b64_tr_b16 v[30:31], v10 offset:6144
    v_mfma_f32_16x16x32_bf16 v[104:107], v[56:59], v[164:167], v[104:107]
    v_add_u32 v11, 0x6000, v11
    v_mfma_f32_16x16x32_bf16 v[108:111], v[56:59], v[228:231], v[108:111]
    ds_read_b64_tr_b16 v[32:33], v11 offset:0
    v_mfma_f32_16x16x32_bf16 v[68:71], v[56:59], v[4:7], v[68:71]
    ds_read_b64_tr_b16 v[34:35], v11 offset:6144
    v_mfma_f32_16x16x32_bf16 v[112:115], v[60:63], v[164:167], v[112:115]
    v_add_u32 v12, 0x6000, v12
    v_mfma_f32_16x16x32_bf16 v[116:119], v[60:63], v[228:231], v[116:119]
    ds_read_b64_tr_b16 v[36:37], v12 offset:0
    v_mfma_f32_16x16x32_bf16 v[72:75], v[60:63], v[4:7], v[72:75]
    ds_read_b64_tr_b16 v[38:39], v12 offset:6144
    v_mfma_f32_16x16x32_bf16 v[120:123], v[64:67], v[164:167], v[120:123]
    v_add_u32 v13, 0x6000, v13
    v_mfma_f32_16x16x32_bf16 v[124:127], v[64:67], v[228:231], v[124:127]
    ds_read_b64_tr_b16 v[40:41], v13 offset:0
    v_mfma_f32_16x16x32_bf16 v[76:79], v[64:67], v[4:7], v[76:79]
    ds_read_b64_tr_b16 v[42:43], v13 offset:6144
    s_waitcnt lgkmcnt(0)
    ds_read_b32 v1, v19 offset:152
    v_mfma_f32_16x16x32_bf16 v[80:83], v[20:23], v[168:171], v[80:83]
    ds_read_b64_tr_b16 v[44:45], v8 offset:12288
    v_mfma_f32_16x16x32_bf16 v[84:87], v[20:23], v[232:235], v[84:87]
    ds_read_b64_tr_b16 v[46:47], v8 offset:18432
    v_mfma_f32_16x16x32_bf16 v[88:91], v[24:27], v[168:171], v[88:91]
    ds_read_b64_tr_b16 v[48:49], v9 offset:12288
    v_mfma_f32_16x16x32_bf16 v[92:95], v[24:27], v[232:235], v[92:95]
    ds_read_b64_tr_b16 v[50:51], v9 offset:18432
    v_mfma_f32_16x16x32_bf16 v[96:99], v[28:31], v[168:171], v[96:99]
    ds_read_b64_tr_b16 v[52:53], v10 offset:12288
    v_mfma_f32_16x16x32_bf16 v[100:103], v[28:31], v[232:235], v[100:103]
    ds_read_b64_tr_b16 v[54:55], v10 offset:18432
    v_mfma_f32_16x16x32_bf16 v[104:107], v[32:35], v[168:171], v[104:107]
    ds_read_b64_tr_b16 v[56:57], v11 offset:12288
    v_mfma_f32_16x16x32_bf16 v[108:111], v[32:35], v[232:235], v[108:111]
    ds_read_b64_tr_b16 v[58:59], v11 offset:18432
    v_mfma_f32_16x16x32_bf16 v[68:71], v[32:35], v[4:7], v[68:71]
    ds_read_b64_tr_b16 v[60:61], v12 offset:12288
    s_waitcnt lgkmcnt(9)
    v_readfirstlane_b32 s66, v1
    s_nop 2
    s_cmp_ge_u32 s66, 4
    s_cbranch_scc1 Lsd_7
    s_mov_b32 s82, 4000000
Lsp_6:
    ds_read_b32 v1, v19 offset:152
    s_waitcnt lgkmcnt(0)
    v_readfirstlane_b32 s66, v1
    s_nop 2
    s_cmp_ge_u32 s66, 4
    s_cbranch_scc1 Lsd_7
    s_sub_u32 s82, s82, 1
    s_cmp_lg_u32 s82, 0
    s_cbranch_scc1 Lsp_6
Lsd_7:
    v_mfma_f32_16x16x32_bf16 v[112:115], v[36:39], v[168:171], v[112:115]
    ds_read_b64_tr_b16 v[62:63], v12 offset:18432
    v_mfma_f32_16x16x32_bf16 v[116:119], v[36:39], v[232:235], v[116:119]
    ds_read_b64_tr_b16 v[64:65], v13 offset:12288
    v_mfma_f32_16x16x32_bf16 v[72:75], v[36:39], v[4:7], v[72:75]
    ds_read_b64_tr_b16 v[66:67], v13 offset:18432
    v_mfma_f32_16x16x32_bf16 v[120:123], v[40:43], v[168:171], v[120:123]
    v_mfma_f32_16x16x32_bf16 v[124:127], v[40:43], v[232:235], v[124:127]
    v_mfma_f32_16x16x32_bf16 v[76:79], v[40:43], v[4:7], v[76:79]
    s_waitcnt lgkmcnt(0)
    s_mov_b64 exec, 1
    ds_add_u32 v19, v3 offset:180
    s_mov_b64 exec, -1
    v_mfma_f32_16x16x32_bf16 v[80:83], v[44:47], v[172:175], v[80:83]
    v_add_u32 v8, 0xfffea000, v8
    ds_read_b64_tr_b16 v[20:21], v8 offset:0
    v_mfma_f32_16x16x32_bf16 v[84:87], v[44:47], v[236:239], v[84:87]
    ds_read_b64_tr_b16 v[22:23], v8 offset:6144
    v_add_u32 v9, 0xfffea000, v9
    v_mfma_f32_16x16x32_bf16 v[88:91], v[48:51], v[172:175], v[88:91]
    ds_read_b64_tr_b16 v[24:25], v9 offset:0
    ds_read_b64_tr_b16 v[26:27], v9 offset:6144
    v_mfma_f32_16x16x32_bf16 v[92:95], v[48:51], v[236:239], v[92:95]
    v_add_u32 v10, 0xfffea000, v10
    v_mfma_f32_16x16x32_bf16 v[96:99], v[52:55], v[172:175], v[96:99]
    ds_read_b64_tr_b16 v[28:29], v10 offset:0
    v_mfma_f32_16x16x32_bf16 v[100:103], v[52:55], v[236:239], v[100:103]
    ds_read_b64_tr_b16 v[30:31], v10 offset:6144
    v_mfma_f32_16x16x32_bf16 v[104:107], v[56:59], v[172:175], v[104:107]
    v_add_u32 v11, 0xfffea000, v11
    v_mfma_f32_16x16x32_bf16 v[108:111], v[56:59], v[236:239], v[108:111]
    ds_read_b64_tr_b16 v[32:33], v11 offset:0
    v_mfma_f32_16x16x32_bf16 v[68:71], v[56:59], v[4:7], v[68:71]
    ds_read_b64_tr_b16 v[34:35], v11 offset:6144
    v_mfma_f32_16x16x32_bf16 v[112:115], v[60:63], v[172:175], v[112:115]
    v_add_u32 v12, 0xfffea000, v12
    v_mfma_f32_16x16x32_bf16 v[116:119], v[60:63], v[236:239], v[116:119]
    ds_read_b64_tr_b16 v[36:37], v12 offset:0
    v_mfma_f32_16x16x32_bf16 v[72:75], v[60:63], v[4:7], v[72:75]
    ds_read_b64_tr_b16 v[38:39], v12 offset:6144
    v_mfma_f32_16x16x32_bf16 v[120:123], v[64:67], v[172:175], v[120:123]
    v_add_u32 v13, 0xfffea000, v13
    v_mfma_f32_16x16x32_bf16 v[124:127], v[64:67], v[236:239], v[124:127]
    ds_read_b64_tr_b16 v[40:41], v13 offset:0
    v_mfma_f32_16x16x32_bf16 v[76:79], v[64:67], v[4:7], v[76:79]
    ds_read_b64_tr_b16 v[42:43], v13 offset:6144
    s_waitcnt lgkmcnt(0)
    ds_read_b32 v1, v19 offset:156
    v_mfma_f32_16x16x32_bf16 v[80:83], v[20:23], v[176:179], v[80:83]
    ds_read_b64_tr_b16 v[44:45], v8 offset:12288
    v_mfma_f32_16x16x32_bf16 v[84:87], v[20:23], v[240:243], v[84:87]
    ds_read_b64_tr_b16 v[46:47], v8 offset:18432
    v_mfma_f32_16x16x32_bf16 v[88:91], v[24:27], v[176:179], v[88:91]
    ds_read_b64_tr_b16 v[48:49], v9 offset:12288
    v_mfma_f32_16x16x32_bf16 v[92:95], v[24:27], v[240:243], v[92:95]
    ds_read_b64_tr_b16 v[50:51], v9 offset:18432
    v_mfma_f32_16x16x32_bf16 v[96:99], v[28:31], v[176:179], v[96:99]
    ds_read_b64_tr_b16 v[52:53], v10 offset:12288
    v_mfma_f32_16x16x32_bf16 v[100:103], v[28:31], v[240:243], v[100:103]
    ds_read_b64_tr_b16 v[54:55], v10 offset:18432
    v_mfma_f32_16x16x32_bf16 v[104:107], v[32:35], v[176:179], v[104:107]
    ds_read_b64_tr_b16 v[56:57], v11 offset:12288
    v_mfma_f32_16x16x32_bf16 v[108:111], v[32:35], v[240:243], v[108:111]
    ds_read_b64_tr_b16 v[58:59], v11 offset:18432
    v_mfma_f32_16x16x32_bf16 v[68:71], v[32:35], v[4:7], v[68:71]
    ds_read_b64_tr_b16 v[60:61], v12 offset:12288
    s_waitcnt lgkmcnt(9)
    v_readfirstlane_b32 s66, v1
    s_nop 2
    s_cmp_ge_u32 s66, 4
    s_cbranch_scc1 Lsd_9
    s_mov_b32 s82, 4000000
Lsp_8:
    ds_read_b32 v1, v19 offset:156
    s_waitcnt lgkmcnt(0)
    v_readfirstlane_b32 s66, v1
    s_nop 2
    s_cmp_ge_u32 s66, 4
    s_cbranch_scc1 Lsd_9
    s_sub_u32 s82, s82, 1
    s_cmp_lg_u32 s82, 0
    s_cbranch_scc1 Lsp_8
Lsd_9:
    v_mfma_f32_16x16x32_bf16 v[112:115], v[36:39], v[176:179], v[112:115]
    ds_read_b64_tr_b16 v[62:63], v12 offset:18432
    v_mfma_f32_16x16x32_bf16 v[116:119], v[36:39], v[240:243], v[116:119]
    ds_read_b64_tr_b16 v[64:65], v13 offset:12288
    v_mfma_f32_16x16x32_bf16 v[72:75], v[36:39], v[4:7], v[72:75]
    ds_read_b64_tr_b16 v[66:67], v13 offset:18432
    v_mfma_f32_16x16x32_bf16 v[120:123], v[40:43], v[176:179], v[120:123]
    v_mfma_f32_16x16x32_bf16 v[124:127], v[40:43], v[240:243], v[124:127]
    v_mfma_f32_16x16x32_bf16 v[76:79], v[40:43], v[4:7], v[76:79]
    s_waitcnt lgkmcnt(0)
    v_mfma_f32_16x16x32_bf16 v[80:83], v[44:47], v[180:183], v[80:83]
    v_add_u32 v8, 0x6000, v8
    ds_read_b64_tr_b16 v[20:21], v8 offset:0
    v_mfma_f32_16x16x32_bf16 v[84:87], v[44:47], v[244:247], v[84:87]
    ds_read_b64_tr_b16 v[22:23], v8 offset:6144
    v_add_u32 v9, 0x6000, v9
    v_mfma_f32_16x16x32_bf16 v[88:91], v[48:51], v[180:183], v[88:91]
    ds_read_b64_tr_b16 v[24:25], v9 offset:0
    ds_read_b64_tr_b16 v[26:27], v9 offset:6144
    v_mfma_f32_16x16x32_bf16 v[92:95], v[48:51], v[244:247], v[92:95]
    v_add_u32 v10, 0x6000, v10
    v_mfma_f32_16x16x32_bf16 v[96:99], v[52:55], v[180:183], v[96:99]
    ds_read_b64_tr_b16 v[28:29], v10 offset:0
    v_mfma_f32_16x16x32_bf16 v[100:103], v[52:55], v[244:247], v[100:103]
    ds_read_b64_tr_b16 v[30:31], v10 offset:6144
    v_mfma_f32_16x16x32_bf16 v[104:107], v[56:59], v[180:183], v[104:107]
    v_add_u32 v11, 0x6000, v11
    v_mfma_f32_16x16x32_bf16 v[108:111], v[56:59], v[244:247], v[108:111]
    ds_read_b64_tr_b16 v[32:33], v11 offset:0
    v_mfma_f32_16x16x32_bf16 v[68:71], v[56:59], v[4:7], v[68:71]
    ds_read_b64_tr_b16 v[34:35], v11 offset:6144
    v_mfma_f32_16x16x32_bf16 v[112:115], v[60:63], v[180:183], v[112:115]
    v_add_u32 v12, 0x6000, v12
    v_mfma_f32_16x16x32_bf16 v[116:119], v[60:63], v[244:247], v[116:119]
    ds_read_b64_tr_b16 v[36:37], v12 offset:0
    v_mfma_f32_16x16x32_bf16 v[72:75], v[60:63], v[4:7], v[72:75]
    ds_read_b64_tr_b16 v[38:39], v12 offset:6144
    v_mfma_f32_16x16x32_bf16 v[120:123], v[64:67], v[180:183], v[120:123]
    v_add_u32 v13, 0x6000, v13
    v_mfma_f32_16x16x32_bf16 v[124:127], v[64:67], v[244:247], v[124:127]
    ds_read_b64_tr_b16 v[40:41], v13 offset:0
    v_mfma_f32_16x16x32_bf16 v[76:79], v[64:67], v[4:7], v[76:79]
    ds_read_b64_tr_b16 v[42:43], v13 offset:6144
    s_waitcnt lgkmcnt(0)
    v_mfma_f32_16x16x32_bf16 v[80:83], v[20:23], v[184:187], v[80:83]
    ds_read_b64_tr_b16 v[44:45], v8 offset:12288
    v_mfma_f32_16x16x32_bf16 v[84:87], v[20:23], v[248:251], v[84:87]
    ds_read_b64_tr_b16 v[46:47], v8 offset:18432
    v_mfma_f32_16x16x32_bf16 v[88:91], v[24:27], v[184:187], v[88:91]
    ds_read_b64_tr_b16 v[48:49], v9 offset:12288
    v_mfma_f32_16x16x32_bf16 v[92:95], v[24:27], v[248:251], v[92:95]
    ds_read_b64_tr_b16 v[50:51], v9 offset:18432
    v_mfma_f32_16x16x32_bf16 v[96:99], v[28:31], v[184:187], v[96:99]
    ds_read_b64_tr_b16 v[52:53], v10 offset:12288
    v_mfma_f32_16x16x32_bf16 v[100:103], v[28:31], v[248:251], v[100:103]
    ds_read_b64_tr_b16 v[54:55], v10 offset:18432
    v_mfma_f32_16x16x32_bf16 v[104:107], v[32:35], v[184:187], v[104:107]
    ds_read_b64_tr_b16 v[56:57], v11 offset:12288
    v_mfma_f32_16x16x32_bf16 v[108:111], v[32:35], v[248:251], v[108:111]
    ds_read_b64_tr_b16 v[58:59], v11 offset:18432
    v_mfma_f32_16x16x32_bf16 v[68:71], v[32:35], v[4:7], v[68:71]
    ds_read_b64_tr_b16 v[60:61], v12 offset:12288
    v_mfma_f32_16x16x32_bf16 v[112:115], v[36:39], v[184:187], v[112:115]
    ds_read_b64_tr_b16 v[62:63], v12 offset:18432
    v_mfma_f32_16x16x32_bf16 v[116:119], v[36:39], v[248:251], v[116:119]
    ds_read_b64_tr_b16 v[64:65], v13 offset:12288
    v_mfma_f32_16x16x32_bf16 v[72:75], v[36:39], v[4:7], v[72:75]
    ds_read_b64_tr_b16 v[66:67], v13 offset:18432
    v_mfma_f32_16x16x32_bf16 v[120:123], v[40:43], v[184:187], v[120:123]
    v_mfma_f32_16x16x32_bf16 v[124:127], v[40:43], v[248:251], v[124:127]
    v_mfma_f32_16x16x32_bf16 v[76:79], v[40:43], v[4:7], v[76:79]
    s_waitcnt lgkmcnt(0)
    v_mfma_f32_16x16x32_bf16 v[80:83], v[44:47], v[188:191], v[80:83]
    v_mfma_f32_16x16x32_bf16 v[84:87], v[44:47], v[252:255], v[84:87]
    v_mfma_f32_16x16x32_bf16 v[88:91], v[48:51], v[188:191], v[88:91]
    v_mfma_f32_16x16x32_bf16 v[92:95], v[48:51], v[252:255], v[92:95]
    v_mfma_f32_16x16x32_bf16 v[96:99], v[52:55], v[188:191], v[96:99]
    v_mfma_f32_16x16x32_bf16 v[100:103], v[52:55], v[252:255], v[100:103]
    v_mfma_f32_16x16x32_bf16 v[104:107], v[56:59], v[188:191], v[104:107]
    v_mfma_f32_16x16x32_bf16 v[108:111], v[56:59], v[252:255], v[108:111]
    v_mfma_f32_16x16x32_bf16 v[68:71], v[56:59], v[4:7], v[68:71]
    v_mfma_f32_16x16x32_bf16 v[112:115], v[60:63], v[188:191], v[112:115]
    v_mfma_f32_16x16x32_bf16 v[116:119], v[60:63], v[252:255], v[116:119]
    v_mfma_f32_16x16x32_bf16 v[72:75], v[60:63], v[4:7], v[72:75]
    v_mfma_f32_16x16x32_bf16 v[120:123], v[64:67], v[188:191], v[120:123]
    v_mfma_f32_16x16x32_bf16 v[124:127], v[64:67], v[252:255], v[124:127]
    v_mfma_f32_16x16x32_bf16 v[76:79], v[64:67], v[4:7], v[76:79]
    v_lshrrev_b32 v1, 4, v0
    v_lshlrev_b32 v1, 4, v1
    s_mul_i32 s62, s58, 384
    s_add_u32 s62, s62, 150720
    v_add_u32 v1, s62, v1
    v_and_b32 v2, 15, v0
    v_cmp_eq_u32 vcc, 0, v2
    s_nop 2
    s_and_saveexec_b64 s[74:75], vcc
    ds_write_b128 v1, v[68:71] offset:0
    ds_write_b128 v1, v[72:75] offset:64
    ds_write_b128 v1, v[76:79] offset:128
    s_mov_b64 exec, s[74:75]
    s_waitcnt lgkmcnt(0)
L_gdone:
    v_mov_b32 v1, 152076
    v_mov_b32 v2, 1
    s_mov_b64 s[74:75], exec
    s_mov_b64 exec, 1
    ds_add_u32 v1, v2
    s_mov_b64 exec, s[74:75]
    s_mov_b32 s40, s24
    s_and_b32 s41, s25, 0xffff
    s_mov_b32 s42, 1409024
    s_mov_b32 s43, 0x20000
    v_mov_b32 v1, 152096
    ds_read_b32 v1, v1
    s_waitcnt lgkmcnt(0)
    v_readfirstlane_b32 s34, v1
    s_and_b32 s62, s2, 7
    s_lshr_b32 s63, s2, 3
    s_lshl_b32 s76, s62, 2
    s_and_b32 s64, s63, 3
    s_add_u32 s76, s76, s64
    s_lshr_b32 s77, s63, 2
    s_mul_i32 s62, s3, 11
    s_cmp_eq_u32 s3, 3
    s_cselect_b32 s63, 10, 11
    s_lshl_b32 s81, s3, 14
    s_add_u32 s81, s81, 34816
    s_mul_i32 s64, s77, 1
    s_cmp_ge_u32 s64, s63
    s_cselect_b32 s65, s63, 0
    s_sub_u32 s64, s64, s65
    s_cmp_ge_u32 s64, s63
    s_cselect_b32 s65, s63, 0
    s_sub_u32 s64, s64, s65
    s_add_u32 s66, s64, 0
    s_cmp_ge_u32 s66, s63
    s_cselect_b32 s65, s63, 0
    s_sub_u32 s66, s66, s65
    s_add_u32 s84, s66, s62
    s_add_u32 s66, s64, 1
    s_cmp_ge_u32 s66, s63
    s_cselect_b32 s65, s63, 0
    s_sub_u32 s66, s66, s65
    s_add_u32 s85, s66, s62
    s_add_u32 s66, s64, 2
    s_cmp_ge_u32 s66, s63
    s_cselect_b32 s65, s63, 0
    s_sub_u32 s66, s66, s65
    s_add_u32 s86, s66, s62
    s_add_u32 s66, s64, 3
    s_cmp_ge_u32 s66, s63
    s_cselect_b32 s65, s63, 0
    s_sub_u32 s66, s66, s65
    s_add_u32 s87, s66, s62
    s_add_u32 s66, s64, 4
    s_cmp_ge_u32 s66, s63
    s_cselect_b32 s65, s63, 0
    s_sub_u32 s66, s66, s65
    s_add_u32 s88, s66, s62
    s_add_u32 s66, s64, 5
    s_cmp_ge_u32 s66, s63
    s_cselect_b32 s65, s63, 0
    s_sub_u32 s66, s66, s65
    s_add_u32 s89, s66, s62
    s_add_u32 s66, s64, 6
    s_cmp_ge_u32 s66, s63
    s_cselect_b32 s65, s63, 0
    s_sub_u32 s66, s66, s65
    s_add_u32 s90, s66, s62
    s_add_u32 s66, s64, 7
    s_cmp_ge_u32 s66, s63
    s_cselect_b32 s65, s63, 0
    s_sub_u32 s66, s66, s65
    s_add_u32 s91, s66, s62
    s_add_u32 s66, s64, 8
    s_cmp_ge_u32 s66, s63
    s_cselect_b32 s65, s63, 0
    s_sub_u32 s66, s66, s65
    s_add_u32 s92, s66, s62
    s_add_u32 s66, s64, 9
    s_cmp_ge_u32 s66, s63
    s_cselect_b32 s65, s63, 0
    s_sub_u32 s66, s66, s65
    s_add_u32 s93, s66, s62
    s_add_u32 s66, s64, 10
    s_cmp_ge_u32 s66, s63
    s_cselect_b32 s65, s63, 0
    s_sub_u32 s66, s66, s65
    s_add_u32 s94, s66, s62
    s_lshl_b32 s80, s77, 7
    s_mov_b32 s95, s63
    v_lshrrev_b32 v1, 3, v0
    v_lshlrev_b32 v1, 10, v1
    v_lshrrev_b32 v2, 4, v0
    v_and_b32 v2, 3, v2
    v_lshlrev_b32 v2, 1, v2
    v_and_b32 v3, 7, v0
    v_xor_b32 v2, v2, v3
    v_lshl_add_u32 v18, v2, 4, v1
    v_mov_b32 v1, 152076
    s_mov_b32 s82, 2000000
Lwc_10:
    ds_read_b32 v2, v1
    s_waitcnt lgkmcnt(0)
    v_readfirstlane_b32 s66, v2
    s_nop 2
    s_cmp_ge_u32 s66, 4
    s_cbranch_scc1 Lwd_11
    s_sleep 1
    s_sub_u32 s82, s82, 1
    s_cmp_lg_u32 s82, 0
    s_cbranch_scc1 Lwc_10
Lwd_11:
    s_setprio 2
    v_and_b32 v1, 15, v0
    s_lshl_b32 s62, s59, 8
    s_add_u32 s62, s62, 149504
    v_lshl_add_u32 v2, v1, 4, s62
    ds_read_b64 v[20:21], v2
    s_lshl_b32 s62, s60, 8
    s_add_u32 s62, s62, 149504
    v_lshl_add_u32 v2, v1, 4, s62
    ds_read_b64 v[22:23], v2
    v_lshrrev_b32 v2, 4, v0
    v_lshlrev_b32 v2, 4, v2
    v_add_u32 v2, 150528, v2
    s_mul_i32 s62, s58, 384
    v_add_u32 v2, s62, v2
    v_lshlrev_b32 v3, 4, v0
    s_mul_i32 s66, s52, 176128
    s_add_u32 s66, s66, 1048576
    ds_read_b128 v[24:27], v2 offset:0
    ds_read_b128 v[56:59], v2 offset:768
    ds_read_b128 v[28:31], v2 offset:64
    ds_read_b128 v[60:63], v2 offset:832
    s_waitcnt lgkmcnt(4)
    v_mov_b32 v14, v21
    v_mul_f32 v15, v20, v21
    v_sub_f32 v15, 0, v15
    v_mov_b32 v16, v23
    v_mul_f32 v17, v22, v23
    v_sub_f32 v17, 0, v17
    s_waitcnt lgkmcnt(0)
    ds_read_b128 v[64:67], v2 offset:128
    ds_read_b128 v[72:75], v2 offset:896
    ds_read_b128 v[68:71], v2 offset:192
    ds_read_b128 v[76:79], v2 offset:960
    s_mul_i32 s62, s58, 3
    s_add_u32 s62, s62, 0
    s_add_u32 s64, s62, s54
    s_lshl_b32 s64, s64, 12
    s_add_u32 s64, s64, s66
    v_pk_fma_f32 v[32:33], v[14:15], v[24:25], v[56:57] op_sel:[1,0,0] op_sel_hi:[1,1,1]
    v_pk_fma_f32 v[34:35], v[14:15], v[26:27], v[58:59] op_sel:[1,0,0] op_sel_hi:[1,1,1]
    v_pk_fma_f32 v[36:37], v[14:15], v[28:29], v[60:61] op_sel:[1,0,0] op_sel_hi:[1,1,1]
    v_pk_fma_f32 v[38:39], v[14:15], v[30:31], v[62:63] op_sel:[1,0,0] op_sel_hi:[1,1,1]
    v_pk_fma_f32 v[80:81], v[80:81], v[14:15], v[32:33] op_sel:[0,0,0] op_sel_hi:[1,0,1]
    v_pk_fma_f32 v[82:83], v[82:83], v[14:15], v[34:35] op_sel:[0,0,0] op_sel_hi:[1,0,1]
    v_pk_fma_f32 v[88:89], v[88:89], v[14:15], v[36:37] op_sel:[0,0,0] op_sel_hi:[1,0,1]
    v_pk_fma_f32 v[90:91], v[90:91], v[14:15], v[38:39] op_sel:[0,0,0] op_sel_hi:[1,0,1]
    s_lshl_b32 s69, s84, 15
    s_add_u32 s69, s69, s80
    s_add_u32 m0, s81, 0
    s_add_u32 s68, s69, 0
    buffer_load_dwordx4 v18, s[40:43], s68 offen lds
    v_pk_mul_f32 v[40:41], v[80:81], v[80:81]
    v_pk_mul_f32 v[42:43], v[82:83], v[82:83]
    v_pk_mul_f32 v[44:45], v[88:89], v[88:89]
    v_pk_mul_f32 v[46:47], v[90:91], v[90:91]
    v_pk_fma_f32 v[40:41], v[40:41], s[70:71], s[70:71] op_sel:[0,1,0] op_sel_hi:[1,1,0]
    v_pk_fma_f32 v[42:43], v[42:43], s[70:71], s[70:71] op_sel:[0,1,0] op_sel_hi:[1,1,0]
    v_pk_fma_f32 v[44:45], v[44:45], s[70:71], s[70:71] op_sel:[0,1,0] op_sel_hi:[1,1,0]
    v_pk_fma_f32 v[46:47], v[46:47], s[70:71], s[70:71] op_sel:[0,1,0] op_sel_hi:[1,1,0]
    s_add_u32 m0, s81, 1024
    s_add_u32 s68, s69, 8192
    buffer_load_dwordx4 v18, s[40:43], s68 offen lds
    v_pk_mul_f32 v[40:41], v[40:41], v[80:81]
    v_pk_mul_f32 v[42:43], v[42:43], v[82:83]
    v_pk_mul_f32 v[44:45], v[44:45], v[88:89]
    v_pk_mul_f32 v[46:47], v[46:47], v[90:91]
    v_exp_f32 v40, v40
    v_exp_f32 v41, v41
    v_exp_f32 v42, v42
    v_exp_f32 v43, v43
    v_exp_f32 v44, v44
    v_exp_f32 v45, v45
    v_exp_f32 v46, v46
    v_exp_f32 v47, v47
    s_add_u32 m0, s81, 2048
    s_add_u32 s68, s69, 16384
    buffer_load_dwordx4 v18, s[40:43], s68 offen lds
    v_pk_add_f32 v[40:41], v[40:41], s[72:73]
    v_pk_add_f32 v[42:43], v[42:43], s[72:73]
    v_pk_add_f32 v[44:45], v[44:45], s[72:73]
    v_pk_add_f32 v[46:47], v[46:47], s[72:73]
    v_rcp_f32 v40, v40
    v_rcp_f32 v41, v41
    v_rcp_f32 v42, v42
    v_rcp_f32 v43, v43
    v_rcp_f32 v44, v44
    v_rcp_f32 v45, v45
    v_rcp_f32 v46, v46
    v_rcp_f32 v47, v47
    s_add_u32 m0, s81, 3072
    s_add_u32 s68, s69, 24576
    buffer_load_dwordx4 v18, s[40:43], s68 offen lds
    v_pk_mul_f32 v[80:81], v[80:81], v[40:41]
    v_pk_mul_f32 v[82:83], v[82:83], v[42:43]
    v_pk_mul_f32 v[88:89], v[88:89], v[44:45]
    v_pk_mul_f32 v[90:91], v[90:91], v[46:47]
    v_cvt_pk_bf16_f32 v48, v80, v81
    v_cvt_pk_bf16_f32 v49, v82, v83
    v_cvt_pk_bf16_f32 v50, v88, v89
    v_cvt_pk_bf16_f32 v51, v90, v91
    s_lshl_b32 s65, s59, 10
    s_add_u32 s65, s65, s64
    buffer_store_dwordx4 v[48:51], v3, s[44:47], s65 offen sc1
    v_pk_fma_f32 v[32:33], v[16:17], v[24:25], v[56:57] op_sel:[1,0,0] op_sel_hi:[1,1,1]
    v_pk_fma_f32 v[34:35], v[16:17], v[26:27], v[58:59] op_sel:[1,0,0] op_sel_hi:[1,1,1]
    v_pk_fma_f32 v[36:37], v[16:17], v[28:29], v[60:61] op_sel:[1,0,0] op_sel_hi:[1,1,1]
    v_pk_fma_f32 v[38:39], v[16:17], v[30:31], v[62:63] op_sel:[1,0,0] op_sel_hi:[1,1,1]
    v_pk_fma_f32 v[84:85], v[84:85], v[16:17], v[32:33] op_sel:[0,0,0] op_sel_hi:[1,0,1]
    v_pk_fma_f32 v[86:87], v[86:87], v[16:17], v[34:35] op_sel:[0,0,0] op_sel_hi:[1,0,1]
    v_pk_fma_f32 v[92:93], v[92:93], v[16:17], v[36:37] op_sel:[0,0,0] op_sel_hi:[1,0,1]
    v_pk_fma_f32 v[94:95], v[94:95], v[16:17], v[38:39] op_sel:[0,0,0] op_sel_hi:[1,0,1]
    s_lshl_b32 s69, s85, 15
    s_add_u32 s69, s69, s80
    s_add_u32 m0, s81, 4096
    s_add_u32 s68, s69, 0
    buffer_load_dwordx4 v18, s[40:43], s68 offen lds
    v_pk_mul_f32 v[40:41], v[84:85], v[84:85]
    v_pk_mul_f32 v[42:43], v[86:87], v[86:87]
    v_pk_mul_f32 v[44:45], v[92:93], v[92:93]
    v_pk_mul_f32 v[46:47], v[94:95], v[94:95]
    v_pk_fma_f32 v[40:41], v[40:41], s[70:71], s[70:71] op_sel:[0,1,0] op_sel_hi:[1,1,0]
    v_pk_fma_f32 v[42:43], v[42:43], s[70:71], s[70:71] op_sel:[0,1,0] op_sel_hi:[1,1,0]
    v_pk_fma_f32 v[44:45], v[44:45], s[70:71], s[70:71] op_sel:[0,1,0] op_sel_hi:[1,1,0]
    v_pk_fma_f32 v[46:47], v[46:47], s[70:71], s[70:71] op_sel:[0,1,0] op_sel_hi:[1,1,0]
    s_add_u32 m0, s81, 5120
    s_add_u32 s68, s69, 8192
    buffer_load_dwordx4 v18, s[40:43], s68 offen lds
    v_pk_mul_f32 v[40:41], v[40:41], v[84:85]
    v_pk_mul_f32 v[42:43], v[42:43], v[86:87]
    v_pk_mul_f32 v[44:45], v[44:45], v[92:93]
    v_pk_mul_f32 v[46:47], v[46:47], v[94:95]
    v_exp_f32 v40, v40
    v_exp_f32 v41, v41
    v_exp_f32 v42, v42
    v_exp_f32 v43, v43
    v_exp_f32 v44, v44
    v_exp_f32 v45, v45
    v_exp_f32 v46, v46
    v_exp_f32 v47, v47
    s_add_u32 m0, s81, 6144
    s_add_u32 s68, s69, 16384
    buffer_load_dwordx4 v18, s[40:43], s68 offen lds
    v_pk_add_f32 v[40:41], v[40:41], s[72:73]
    v_pk_add_f32 v[42:43], v[42:43], s[72:73]
    v_pk_add_f32 v[44:45], v[44:45], s[72:73]
    v_pk_add_f32 v[46:47], v[46:47], s[72:73]
    v_rcp_f32 v40, v40
    v_rcp_f32 v41, v41
    v_rcp_f32 v42, v42
    v_rcp_f32 v43, v43
    v_rcp_f32 v44, v44
    v_rcp_f32 v45, v45
    v_rcp_f32 v46, v46
    v_rcp_f32 v47, v47
    s_add_u32 m0, s81, 7168
    s_add_u32 s68, s69, 24576
    buffer_load_dwordx4 v18, s[40:43], s68 offen lds
    v_pk_mul_f32 v[84:85], v[84:85], v[40:41]
    v_pk_mul_f32 v[86:87], v[86:87], v[42:43]
    v_pk_mul_f32 v[92:93], v[92:93], v[44:45]
    v_pk_mul_f32 v[94:95], v[94:95], v[46:47]
    v_cvt_pk_bf16_f32 v52, v84, v85
    v_cvt_pk_bf16_f32 v53, v86, v87
    v_cvt_pk_bf16_f32 v54, v92, v93
    v_cvt_pk_bf16_f32 v55, v94, v95
    s_lshl_b32 s65, s60, 10
    s_add_u32 s65, s65, s64
    buffer_store_dwordx4 v[52:55], v3, s[44:47], s65 offen sc1
    s_waitcnt lgkmcnt(0)
    ds_read_b128 v[24:27], v2 offset:256
    ds_read_b128 v[56:59], v2 offset:1024
    ds_read_b128 v[28:31], v2 offset:320
    ds_read_b128 v[60:63], v2 offset:1088
    s_mul_i32 s62, s58, 3
    s_add_u32 s62, s62, 1
    s_add_u32 s64, s62, s54
    s_lshl_b32 s64, s64, 12
    s_add_u32 s64, s64, s66
    v_pk_fma_f32 v[32:33], v[14:15], v[64:65], v[72:73] op_sel:[1,0,0] op_sel_hi:[1,1,1]
    v_pk_fma_f32 v[34:35], v[14:15], v[66:67], v[74:75] op_sel:[1,0,0] op_sel_hi:[1,1,1]
    v_pk_fma_f32 v[36:37], v[14:15], v[68:69], v[76:77] op_sel:[1,0,0] op_sel_hi:[1,1,1]
    v_pk_fma_f32 v[38:39], v[14:15], v[70:71], v[78:79] op_sel:[1,0,0] op_sel_hi:[1,1,1]
    v_pk_fma_f32 v[96:97], v[96:97], v[14:15], v[32:33] op_sel:[0,0,0] op_sel_hi:[1,0,1]
    v_pk_fma_f32 v[98:99], v[98:99], v[14:15], v[34:35] op_sel:[0,0,0] op_sel_hi:[1,0,1]
    v_pk_fma_f32 v[104:105], v[104:105], v[14:15], v[36:37] op_sel:[0,0,0] op_sel_hi:[1,0,1]
    v_pk_fma_f32 v[106:107], v[106:107], v[14:15], v[38:39] op_sel:[0,0,0] op_sel_hi:[1,0,1]
    s_lshl_b32 s69, s86, 15
    s_add_u32 s69, s69, s80
    s_add_u32 m0, s81, 8192
    s_add_u32 s68, s69, 0
    buffer_load_dwordx4 v18, s[40:43], s68 offen lds
    v_pk_mul_f32 v[40:41], v[96:97], v[96:97]
    v_pk_mul_f32 v[42:43], v[98:99], v[98:99]
    v_pk_mul_f32 v[44:45], v[104:105], v[104:105]
    v_pk_mul_f32 v[46:47], v[106:107], v[106:107]
    v_pk_fma_f32 v[40:41], v[40:41], s[70:71], s[70:71] op_sel:[0,1,0] op_sel_hi:[1,1,0]
    v_pk_fma_f32 v[42:43], v[42:43], s[70:71], s[70:71] op_sel:[0,1,0] op_sel_hi:[1,1,0]
    v_pk_fma_f32 v[44:45], v[44:45], s[70:71], s[70:71] op_sel:[0,1,0] op_sel_hi:[1,1,0]
    v_pk_fma_f32 v[46:47], v[46:47], s[70:71], s[70:71] op_sel:[0,1,0] op_sel_hi:[1,1,0]
    s_add_u32 m0, s81, 9216
    s_add_u32 s68, s69, 8192
    buffer_load_dwordx4 v18, s[40:43], s68 offen lds
    v_pk_mul_f32 v[40:41], v[40:41], v[96:97]
    v_pk_mul_f32 v[42:43], v[42:43], v[98:99]
    v_pk_mul_f32 v[44:45], v[44:45], v[104:105]
    v_pk_mul_f32 v[46:47], v[46:47], v[106:107]
    v_exp_f32 v40, v40
    v_exp_f32 v41, v41
    v_exp_f32 v42, v42
    v_exp_f32 v43, v43
    v_exp_f32 v44, v44
    v_exp_f32 v45, v45
    v_exp_f32 v46, v46
    v_exp_f32 v47, v47
    s_add_u32 m0, s81, 10240
    s_add_u32 s68, s69, 16384
    buffer_load_dwordx4 v18, s[40:43], s68 offen lds
    v_pk_add_f32 v[40:41], v[40:41], s[72:73]
    v_pk_add_f32 v[42:43], v[42:43], s[72:73]
    v_pk_add_f32 v[44:45], v[44:45], s[72:73]
    v_pk_add_f32 v[46:47], v[46:47], s[72:73]
    v_rcp_f32 v40, v40
    v_rcp_f32 v41, v41
    v_rcp_f32 v42, v42
    v_rcp_f32 v43, v43
    v_rcp_f32 v44, v44
    v_rcp_f32 v45, v45
    v_rcp_f32 v46, v46
    v_rcp_f32 v47, v47
    s_add_u32 m0, s81, 11264
    s_add_u32 s68, s69, 24576
    buffer_load_dwordx4 v18, s[40:43], s68 offen lds
    v_pk_mul_f32 v[96:97], v[96:97], v[40:41]
    v_pk_mul_f32 v[98:99], v[98:99], v[42:43]
    v_pk_mul_f32 v[104:105], v[104:105], v[44:45]
    v_pk_mul_f32 v[106:107], v[106:107], v[46:47]
    v_cvt_pk_bf16_f32 v48, v96, v97
    v_cvt_pk_bf16_f32 v49, v98, v99
    v_cvt_pk_bf16_f32 v50, v104, v105
    v_cvt_pk_bf16_f32 v51, v106, v107
    s_lshl_b32 s65, s59, 10
    s_add_u32 s65, s65, s64
    buffer_store_dwordx4 v[48:51], v3, s[44:47], s65 offen sc1
    v_pk_fma_f32 v[32:33], v[16:17], v[64:65], v[72:73] op_sel:[1,0,0] op_sel_hi:[1,1,1]
    v_pk_fma_f32 v[34:35], v[16:17], v[66:67], v[74:75] op_sel:[1,0,0] op_sel_hi:[1,1,1]
    v_pk_fma_f32 v[36:37], v[16:17], v[68:69], v[76:77] op_sel:[1,0,0] op_sel_hi:[1,1,1]
    v_pk_fma_f32 v[38:39], v[16:17], v[70:71], v[78:79] op_sel:[1,0,0] op_sel_hi:[1,1,1]
    v_pk_fma_f32 v[100:101], v[100:101], v[16:17], v[32:33] op_sel:[0,0,0] op_sel_hi:[1,0,1]
    v_pk_fma_f32 v[102:103], v[102:103], v[16:17], v[34:35] op_sel:[0,0,0] op_sel_hi:[1,0,1]
    v_pk_fma_f32 v[108:109], v[108:109], v[16:17], v[36:37] op_sel:[0,0,0] op_sel_hi:[1,0,1]
    v_pk_fma_f32 v[110:111], v[110:111], v[16:17], v[38:39] op_sel:[0,0,0] op_sel_hi:[1,0,1]
    s_lshl_b32 s69, s87, 15
    s_add_u32 s69, s69, s80
    s_add_u32 m0, s81, 12288
    s_add_u32 s68, s69, 0
    buffer_load_dwordx4 v18, s[40:43], s68 offen lds
    v_pk_mul_f32 v[40:41], v[100:101], v[100:101]
    v_pk_mul_f32 v[42:43], v[102:103], v[102:103]
    v_pk_mul_f32 v[44:45], v[108:109], v[108:109]
    v_pk_mul_f32 v[46:47], v[110:111], v[110:111]
    v_pk_fma_f32 v[40:41], v[40:41], s[70:71], s[70:71] op_sel:[0,1,0] op_sel_hi:[1,1,0]
    v_pk_fma_f32 v[42:43], v[42:43], s[70:71], s[70:71] op_sel:[0,1,0] op_sel_hi:[1,1,0]
    v_pk_fma_f32 v[44:45], v[44:45], s[70:71], s[70:71] op_sel:[0,1,0] op_sel_hi:[1,1,0]
    v_pk_fma_f32 v[46:47], v[46:47], s[70:71], s[70:71] op_sel:[0,1,0] op_sel_hi:[1,1,0]
    s_add_u32 m0, s81, 13312
    s_add_u32 s68, s69, 8192
    buffer_load_dwordx4 v18, s[40:43], s68 offen lds
    v_pk_mul_f32 v[40:41], v[40:41], v[100:101]
    v_pk_mul_f32 v[42:43], v[42:43], v[102:103]
    v_pk_mul_f32 v[44:45], v[44:45], v[108:109]
    v_pk_mul_f32 v[46:47], v[46:47], v[110:111]
    v_exp_f32 v40, v40
    v_exp_f32 v41, v41
    v_exp_f32 v42, v42
    v_exp_f32 v43, v43
    v_exp_f32 v44, v44
    v_exp_f32 v45, v45
    v_exp_f32 v46, v46
    v_exp_f32 v47, v47
    s_add_u32 m0, s81, 14336
    s_add_u32 s68, s69, 16384
    buffer_load_dwordx4 v18, s[40:43], s68 offen lds
    v_pk_add_f32 v[40:41], v[40:41], s[72:73]
    v_pk_add_f32 v[42:43], v[42:43], s[72:73]
    v_pk_add_f32 v[44:45], v[44:45], s[72:73]
    v_pk_add_f32 v[46:47], v[46:47], s[72:73]
    v_rcp_f32 v40, v40
    v_rcp_f32 v41, v41
    v_rcp_f32 v42, v42
    v_rcp_f32 v43, v43
    v_rcp_f32 v44, v44
    v_rcp_f32 v45, v45
    v_rcp_f32 v46, v46
    v_rcp_f32 v47, v47
    s_add_u32 m0, s81, 15360
    s_add_u32 s68, s69, 24576
    buffer_load_dwordx4 v18, s[40:43], s68 offen lds
    v_pk_mul_f32 v[100:101], v[100:101], v[40:41]
    v_pk_mul_f32 v[102:103], v[102:103], v[42:43]
    v_pk_mul_f32 v[108:109], v[108:109], v[44:45]
    v_pk_mul_f32 v[110:111], v[110:111], v[46:47]
    v_cvt_pk_bf16_f32 v52, v100, v101
    v_cvt_pk_bf16_f32 v53, v102, v103
    v_cvt_pk_bf16_f32 v54, v108, v109
    v_cvt_pk_bf16_f32 v55, v110, v111
    s_lshl_b32 s65, s60, 10
    s_add_u32 s65, s65, s64
    buffer_store_dwordx4 v[52:55], v3, s[44:47], s65 offen sc1
    s_waitcnt lgkmcnt(0)
    s_mul_i32 s62, s58, 3
    s_add_u32 s62, s62, 2
    s_add_u32 s64, s62, s54
    s_lshl_b32 s64, s64, 12
    s_add_u32 s64, s64, s66
    s_cmp_ge_u32 s62, s55
    s_cbranch_scc1 Lg1skip_14
    v_pk_fma_f32 v[32:33], v[14:15], v[24:25], v[56:57] op_sel:[1,0,0] op_sel_hi:[1,1,1]
    v_pk_fma_f32 v[34:35], v[14:15], v[26:27], v[58:59] op_sel:[1,0,0] op_sel_hi:[1,1,1]
    v_pk_fma_f32 v[36:37], v[14:15], v[28:29], v[60:61] op_sel:[1,0,0] op_sel_hi:[1,1,1]
    v_pk_fma_f32 v[38:39], v[14:15], v[30:31], v[62:63] op_sel:[1,0,0] op_sel_hi:[1,1,1]
    v_pk_fma_f32 v[112:113], v[112:113], v[14:15], v[32:33] op_sel:[0,0,0] op_sel_hi:[1,0,1]
    v_pk_fma_f32 v[114:115], v[114:115], v[14:15], v[34:35] op_sel:[0,0,0] op_sel_hi:[1,0,1]
    v_pk_fma_f32 v[120:121], v[120:121], v[14:15], v[36:37] op_sel:[0,0,0] op_sel_hi:[1,0,1]
    v_pk_fma_f32 v[122:123], v[122:123], v[14:15], v[38:39] op_sel:[0,0,0] op_sel_hi:[1,0,1]
    v_pk_mul_f32 v[40:41], v[112:113], v[112:113]
    v_pk_mul_f32 v[42:43], v[114:115], v[114:115]
    v_pk_mul_f32 v[44:45], v[120:121], v[120:121]
    v_pk_mul_f32 v[46:47], v[122:123], v[122:123]
    v_pk_fma_f32 v[40:41], v[40:41], s[70:71], s[70:71] op_sel:[0,1,0] op_sel_hi:[1,1,0]
    v_pk_fma_f32 v[42:43], v[42:43], s[70:71], s[70:71] op_sel:[0,1,0] op_sel_hi:[1,1,0]
    v_pk_fma_f32 v[44:45], v[44:45], s[70:71], s[70:71] op_sel:[0,1,0] op_sel_hi:[1,1,0]
    v_pk_fma_f32 v[46:47], v[46:47], s[70:71], s[70:71] op_sel:[0,1,0] op_sel_hi:[1,1,0]
    v_pk_mul_f32 v[40:41], v[40:41], v[112:113]
    v_pk_mul_f32 v[42:43], v[42:43], v[114:115]
    v_pk_mul_f32 v[44:45], v[44:45], v[120:121]
    v_pk_mul_f32 v[46:47], v[46:47], v[122:123]
    v_exp_f32 v40, v40
    v_exp_f32 v41, v41
    v_exp_f32 v42, v42
    v_exp_f32 v43, v43
    v_exp_f32 v44, v44
    v_exp_f32 v45, v45
    v_exp_f32 v46, v46
    v_exp_f32 v47, v47
    v_pk_add_f32 v[40:41], v[40:41], s[72:73]
    v_pk_add_f32 v[42:43], v[42:43], s[72:73]
    v_pk_add_f32 v[44:45], v[44:45], s[72:73]
    v_pk_add_f32 v[46:47], v[46:47], s[72:73]
    v_rcp_f32 v40, v40
    v_rcp_f32 v41, v41
    v_rcp_f32 v42, v42
    v_rcp_f32 v43, v43
    v_rcp_f32 v44, v44
    v_rcp_f32 v45, v45
    v_rcp_f32 v46, v46
    v_rcp_f32 v47, v47
    v_pk_mul_f32 v[112:113], v[112:113], v[40:41]
    v_pk_mul_f32 v[114:115], v[114:115], v[42:43]
    v_pk_mul_f32 v[120:121], v[120:121], v[44:45]
    v_pk_mul_f32 v[122:123], v[122:123], v[46:47]
    v_cvt_pk_bf16_f32 v48, v112, v113
    v_cvt_pk_bf16_f32 v49, v114, v115
    v_cvt_pk_bf16_f32 v50, v120, v121
    v_cvt_pk_bf16_f32 v51, v122, v123
    s_lshl_b32 s65, s59, 10
    s_add_u32 s65, s65, s64
    buffer_store_dwordx4 v[48:51], v3, s[44:47], s65 offen sc1
    v_pk_fma_f32 v[32:33], v[16:17], v[24:25], v[56:57] op_sel:[1,0,0] op_sel_hi:[1,1,1]
    v_pk_fma_f32 v[34:35], v[16:17], v[26:27], v[58:59] op_sel:[1,0,0] op_sel_hi:[1,1,1]
    v_pk_fma_f32 v[36:37], v[16:17], v[28:29], v[60:61] op_sel:[1,0,0] op_sel_hi:[1,1,1]
    v_pk_fma_f32 v[38:39], v[16:17], v[30:31], v[62:63] op_sel:[1,0,0] op_sel_hi:[1,1,1]
    v_pk_fma_f32 v[116:117], v[116:117], v[16:17], v[32:33] op_sel:[0,0,0] op_sel_hi:[1,0,1]
    v_pk_fma_f32 v[118:119], v[118:119], v[16:17], v[34:35] op_sel:[0,0,0] op_sel_hi:[1,0,1]
    v_pk_fma_f32 v[124:125], v[124:125], v[16:17], v[36:37] op_sel:[0,0,0] op_sel_hi:[1,0,1]
    v_pk_fma_f32 v[126:127], v[126:127], v[16:17], v[38:39] op_sel:[0,0,0] op_sel_hi:[1,0,1]
    v_pk_mul_f32 v[40:41], v[116:117], v[116:117]
    v_pk_mul_f32 v[42:43], v[118:119], v[118:119]
    v_pk_mul_f32 v[44:45], v[124:125], v[124:125]
    v_pk_mul_f32 v[46:47], v[126:127], v[126:127]
    v_pk_fma_f32 v[40:41], v[40:41], s[70:71], s[70:71] op_sel:[0,1,0] op_sel_hi:[1,1,0]
    v_pk_fma_f32 v[42:43], v[42:43], s[70:71], s[70:71] op_sel:[0,1,0] op_sel_hi:[1,1,0]
    v_pk_fma_f32 v[44:45], v[44:45], s[70:71], s[70:71] op_sel:[0,1,0] op_sel_hi:[1,1,0]
    v_pk_fma_f32 v[46:47], v[46:47], s[70:71], s[70:71] op_sel:[0,1,0] op_sel_hi:[1,1,0]
    v_pk_mul_f32 v[40:41], v[40:41], v[116:117]
    v_pk_mul_f32 v[42:43], v[42:43], v[118:119]
    v_pk_mul_f32 v[44:45], v[44:45], v[124:125]
    v_pk_mul_f32 v[46:47], v[46:47], v[126:127]
    v_exp_f32 v40, v40
    v_exp_f32 v41, v41
    v_exp_f32 v42, v42
    v_exp_f32 v43, v43
    v_exp_f32 v44, v44
    v_exp_f32 v45, v45
    v_exp_f32 v46, v46
    v_exp_f32 v47, v47
    v_pk_add_f32 v[40:41], v[40:41], s[72:73]
    v_pk_add_f32 v[42:43], v[42:43], s[72:73]
    v_pk_add_f32 v[44:45], v[44:45], s[72:73]
    v_pk_add_f32 v[46:47], v[46:47], s[72:73]
    v_rcp_f32 v40, v40
    v_rcp_f32 v41, v41
    v_rcp_f32 v42, v42
    v_rcp_f32 v43, v43
    v_rcp_f32 v44, v44
    v_rcp_f32 v45, v45
    v_rcp_f32 v46, v46
    v_rcp_f32 v47, v47
    v_pk_mul_f32 v[116:117], v[116:117], v[40:41]
    v_pk_mul_f32 v[118:119], v[118:119], v[42:43]
    v_pk_mul_f32 v[124:125], v[124:125], v[44:45]
    v_pk_mul_f32 v[126:127], v[126:127], v[46:47]
    v_cvt_pk_bf16_f32 v52, v116, v117
    v_cvt_pk_bf16_f32 v53, v118, v119
    v_cvt_pk_bf16_f32 v54, v124, v125
    v_cvt_pk_bf16_f32 v55, v126, v127
    s_lshl_b32 s65, s60, 10
    s_add_u32 s65, s65, s64
    buffer_store_dwordx4 v[52:55], v3, s[44:47], s65 offen sc1
Lg1skip_14:
    v_mov_b32 v1, 152152
    v_mov_b32 v2, 1
    s_mov_b64 s[74:75], exec
    s_mov_b64 exec, 1
    ds_add_u32 v1, v2
    s_mov_b64 exec, s[74:75]
    v_mov_b32 v4, v18
    v_lshrrev_b32 v1, 2, v0
    v_lshlrev_b32 v2, 7, v1
    v_and_b32 v3, 3, v0
    v_lshl_add_u32 v2, v3, 3, v2
    v_lshrrev_b32 v3, 1, v1
    v_and_b32 v3, 3, v3
    v_add_u32 v2, s81, v2
    v_xor_b32 v1, 0, v3
    v_lshl_add_u32 v5, v1, 5, v2
    v_xor_b32 v1, 1, v3
    v_lshl_add_u32 v6, v1, 5, v2
    v_xor_b32 v1, 2, v3
    v_lshl_add_u32 v7, v1, 5, v2
    v_xor_b32 v1, 3, v3
    v_lshl_add_u32 v8, v1, 5, v2
    s_mul_i32 s62, s58, 3
    s_add_u32 s62, s62, 2
    s_cmp_ge_u32 s62, s55
    s_cbranch_scc1 Lw_15
    s_waitcnt vmcnt(3)
    s_branch Lw_16
Lw_15:
    s_waitcnt vmcnt(1)
Lw_16:
    ds_read_b64_tr_b16 v[128:129], v5 offset:0
    ds_read_b64_tr_b16 v[130:131], v5 offset:2048
    ds_read_b64_tr_b16 v[132:133], v6 offset:0
    ds_read_b64_tr_b16 v[134:135], v6 offset:2048
    ds_read_b64_tr_b16 v[136:137], v7 offset:0
    ds_read_b64_tr_b16 v[138:139], v7 offset:2048
    ds_read_b64_tr_b16 v[140:141], v8 offset:0
    ds_read_b64_tr_b16 v[142:143], v8 offset:2048
    ds_read_b64_tr_b16 v[144:145], v5 offset:4096
    ds_read_b64_tr_b16 v[146:147], v5 offset:6144
    ds_read_b64_tr_b16 v[148:149], v6 offset:4096
    ds_read_b64_tr_b16 v[150:151], v6 offset:6144
    s_waitcnt lgkmcnt(3)
    ds_read_b64_tr_b16 v[152:153], v7 offset:4096
    ds_read_b64_tr_b16 v[154:155], v7 offset:6144
    ds_read_b64_tr_b16 v[156:157], v8 offset:4096
    ds_read_b64_tr_b16 v[158:159], v8 offset:6144
    ds_read_b64_tr_b16 v[160:161], v5 offset:8192
    ds_read_b64_tr_b16 v[162:163], v5 offset:10240
    ds_read_b64_tr_b16 v[164:165], v6 offset:8192
    ds_read_b64_tr_b16 v[166:167], v6 offset:10240
    ds_read_b64_tr_b16 v[168:169], v7 offset:8192
    ds_read_b64_tr_b16 v[170:171], v7 offset:10240
    ds_read_b64_tr_b16 v[172:173], v8 offset:8192
    ds_read_b64_tr_b16 v[174:175], v8 offset:10240
    s_waitcnt lgkmcnt(3)
    ds_read_b64_tr_b16 v[176:177], v5 offset:12288
    ds_read_b64_tr_b16 v[178:179], v5 offset:14336
    ds_read_b64_tr_b16 v[180:181], v6 offset:12288
    ds_read_b64_tr_b16 v[182:183], v6 offset:14336
    ds_read_b64_tr_b16 v[184:185], v7 offset:12288
    ds_read_b64_tr_b16 v[186:187], v7 offset:14336
    ds_read_b64_tr_b16 v[188:189], v8 offset:12288
    ds_read_b64_tr_b16 v[190:191], v8 offset:14336
    s_waitcnt lgkmcnt(0)
    s_lshl_b32 s69, s88, 15
    s_add_u32 s69, s69, s80
    s_add_u32 m0, s81, 0
    s_add_u32 s68, s69, 0
    buffer_load_dwordx4 v4, s[40:43], s68 offen lds
    s_add_u32 m0, s81, 1024
    s_add_u32 s68, s69, 8192
    buffer_load_dwordx4 v4, s[40:43], s68 offen lds
    s_add_u32 m0, s81, 2048
    s_add_u32 s68, s69, 16384
    buffer_load_dwordx4 v4, s[40:43], s68 offen lds
    s_add_u32 m0, s81, 3072
    s_add_u32 s68, s69, 24576
    buffer_load_dwordx4 v4, s[40:43], s68 offen lds
    s_lshl_b32 s69, s89, 15
    s_add_u32 s69, s69, s80
    s_add_u32 m0, s81, 4096
    s_add_u32 s68, s69, 0
    buffer_load_dwordx4 v4, s[40:43], s68 offen lds
    s_add_u32 m0, s81, 5120
    s_add_u32 s68, s69, 8192
    buffer_load_dwordx4 v4, s[40:43], s68 offen lds
    s_add_u32 m0, s81, 6144
    s_add_u32 s68, s69, 16384
    buffer_load_dwordx4 v4, s[40:43], s68 offen lds
    s_add_u32 m0, s81, 7168
    s_add_u32 s68, s69, 24576
    buffer_load_dwordx4 v4, s[40:43], s68 offen lds
    s_lshl_b32 s69, s90, 15
    s_add_u32 s69, s69, s80
    s_add_u32 m0, s81, 8192
    s_add_u32 s68, s69, 0
    buffer_load_dwordx4 v4, s[40:43], s68 offen lds
    s_add_u32 m0, s81, 9216
    s_add_u32 s68, s69, 8192
    buffer_load_dwordx4 v4, s[40:43], s68 offen lds
    s_add_u32 m0, s81, 10240
    s_add_u32 s68, s69, 16384
    buffer_load_dwordx4 v4, s[40:43], s68 offen lds
    s_add_u32 m0, s81, 11264
    s_add_u32 s68, s69, 24576
    buffer_load_dwordx4 v4, s[40:43], s68 offen lds
    s_waitcnt vmcnt(12)
    s_lshl_b32 s62, s52, 3
    s_add_u32 s62, s62, s53
    s_lshl_b32 s62, s62, 6
    s_add_u32 s62, s62, 32768
    v_mov_b32 v1, 152068
    v_mov_b32 v2, 1
    s_mov_b64 s[74:75], exec
    s_mov_b64 exec, 1
    ds_add_rtn_u32 v2, v1, v2
    s_waitcnt lgkmcnt(0)
    v_readfirstlane_b32 s68, v2
    s_nop 2
    s_cmp_lg_u32 s68, 3
    s_cbranch_scc1 Lsig_17
    v_mov_b32 v1, 0
    v_mov_b32 v2, s34
    buffer_store_dword v2, v1, s[44:47], s62 offen sc1
Lsig_17:
    s_mov_b64 exec, s[74:75]
    s_setprio 0
    v_lshlrev_b32 v9, 4, v0
    s_mul_i32 s83, s76, 176128
    s_add_u32 s83, s83, 1048576
    s_lshl_b32 s62, s76, 9
    s_add_u32 s78, s62, 32768
    v_lshrrev_b32 v2, 4, v0
    v_lshrrev_b32 v3, 2, v0
    v_and_b32 v3, 3, v3
    v_and_b32 v1, 3, v0
    v_lshlrev_b32 v2, 5, v2
    v_lshl_add_u32 v2, v1, 3, v2
    v_lshl_add_u32 v3, v3, 12, v2
    s_lshl_b32 s62, s76, 16
    s_lshl_b32 s63, s77, 7
    s_add_u32 s62, s62, s63
    s_lshr_b32 s64, s3, 1
    s_lshl_b32 s64, s64, 14
    s_add_u32 s62, s62, s64
    s_and_b32 s64, s3, 1
    s_lshl_b32 s64, s64, 11
    s_add_u32 s62, s62, s64
    v_add_u32 v3, s62, v3
    buffer_load_dwordx2 v[10:11], v3, s[36:39], 0 offen
    buffer_load_dwordx2 v[12:13], v3, s[36:39], 0 offen offset:1024
    v_add_u32 v2, s63, v2
    global_load_dwordx2 v[14:15], v2, s[26:27]
    v_lshlrev_b32 v1, 6, v0
    s_waitcnt vmcnt(3)
    ds_read_b64_tr_b16 v[192:193], v5 offset:0
    ds_read_b64_tr_b16 v[194:195], v5 offset:2048
    ds_read_b64_tr_b16 v[196:197], v6 offset:0
    ds_read_b64_tr_b16 v[198:199], v6 offset:2048
    ds_read_b64_tr_b16 v[200:201], v7 offset:0
    ds_read_b64_tr_b16 v[202:203], v7 offset:2048
    ds_read_b64_tr_b16 v[204:205], v8 offset:0
    ds_read_b64_tr_b16 v[206:207], v8 offset:2048
    ds_read_b64_tr_b16 v[208:209], v5 offset:4096
    ds_read_b64_tr_b16 v[210:211], v5 offset:6144
    ds_read_b64_tr_b16 v[212:213], v6 offset:4096
    ds_read_b64_tr_b16 v[214:215], v6 offset:6144
    s_waitcnt lgkmcnt(3)
    ds_read_b64_tr_b16 v[216:217], v7 offset:4096
    ds_read_b64_tr_b16 v[218:219], v7 offset:6144
    ds_read_b64_tr_b16 v[220:221], v8 offset:4096
    ds_read_b64_tr_b16 v[222:223], v8 offset:6144
    ds_read_b64_tr_b16 v[224:225], v5 offset:8192
    ds_read_b64_tr_b16 v[226:227], v5 offset:10240
    ds_read_b64_tr_b16 v[228:229], v6 offset:8192
    ds_read_b64_tr_b16 v[230:231], v6 offset:10240
    ds_read_b64_tr_b16 v[232:233], v7 offset:8192
    ds_read_b64_tr_b16 v[234:235], v7 offset:10240
    ds_read_b64_tr_b16 v[236:237], v8 offset:8192
    ds_read_b64_tr_b16 v[238:239], v8 offset:10240
    s_waitcnt lgkmcnt(3)
    s_waitcnt lgkmcnt(0)
    s_lshl_b32 s69, s91, 15
    s_add_u32 s69, s69, s80
    s_add_u32 m0, s81, 12288
    s_add_u32 s68, s69, 0
    buffer_load_dwordx4 v4, s[40:43], s68 offen lds
    s_add_u32 m0, s81, 13312
    s_add_u32 s68, s69, 8192
    buffer_load_dwordx4 v4, s[40:43], s68 offen lds
    s_add_u32 m0, s81, 14336
    s_add_u32 s68, s69, 16384
    buffer_load_dwordx4 v4, s[40:43], s68 offen lds
    s_add_u32 m0, s81, 15360
    s_add_u32 s68, s69, 24576
    buffer_load_dwordx4 v4, s[40:43], s68 offen lds
    s_lshl_b32 s69, s92, 15
    s_add_u32 s69, s69, s80
    s_add_u32 m0, s81, 0
    s_add_u32 s68, s69, 0
    buffer_load_dwordx4 v4, s[40:43], s68 offen lds
    s_add_u32 m0, s81, 1024
    s_add_u32 s68, s69, 8192
    buffer_load_dwordx4 v4, s[40:43], s68 offen lds
    s_add_u32 m0, s81, 2048
    s_add_u32 s68, s69, 16384
    buffer_load_dwordx4 v4, s[40:43], s68 offen lds
    s_add_u32 m0, s81, 3072
    s_add_u32 s68, s69, 24576
    buffer_load_dwordx4 v4, s[40:43], s68 offen lds
    s_lshl_b32 s69, s93, 15
    s_add_u32 s69, s69, s80
    s_add_u32 m0, s81, 4096
    s_add_u32 s68, s69, 0
    buffer_load_dwordx4 v4, s[40:43], s68 offen lds
    s_add_u32 m0, s81, 5120
    s_add_u32 s68, s69, 8192
    buffer_load_dwordx4 v4, s[40:43], s68 offen lds
    s_add_u32 m0, s81, 6144
    s_add_u32 s68, s69, 16384
    buffer_load_dwordx4 v4, s[40:43], s68 offen lds
    s_add_u32 m0, s81, 7168
    s_add_u32 s68, s69, 24576
    buffer_load_dwordx4 v4, s[40:43], s68 offen lds
    s_lshl_b32 s69, s94, 15
    s_add_u32 s69, s69, s80
    s_add_u32 m0, s81, 8192
    s_add_u32 s68, s69, 0
    buffer_load_dwordx4 v4, s[40:43], s68 offen lds
    s_add_u32 m0, s81, 9216
    s_add_u32 s68, s69, 8192
    buffer_load_dwordx4 v4, s[40:43], s68 offen lds
    s_add_u32 m0, s81, 10240
    s_add_u32 s68, s69, 16384
    buffer_load_dwordx4 v4, s[40:43], s68 offen lds
    s_add_u32 m0, s81, 11264
    s_add_u32 s68, s69, 24576
    buffer_load_dwordx4 v4, s[40:43], s68 offen lds
    s_mov_b64 s[74:75], exec
    s_mov_b32 exec_lo, 0xff
    s_mov_b32 exec_hi, 0
    s_mov_b32 s82, 200000
Lpoll_18:
    buffer_load_dword v2, v1, s[44:47], s78 offen sc1
    s_waitcnt vmcnt(0)
    v_cmp_ne_u32 vcc, s34, v2
    s_nop 4
    s_cbranch_vccz Lpolld_19
    s_sub_u32 s82, s82, 1
    s_cmp_eq_u32 s82, 0
    s_cbranch_scc1 Lpolld_19
    s_sleep 2
    s_branch Lpoll_18
Lpolld_19:
    s_mov_b64 exec, s[74:75]
    s_lshl_b32 s69, s84, 12
    s_add_u32 s69, s69, s83
    s_add_u32 s68, s69, 0
    buffer_load_dwordx4 v[16:19], v9, s[44:47], s68 offen sc1
    s_add_u32 s68, s69, 1024
    buffer_load_dwordx4 v[20:23], v9, s[44:47], s68 offen sc1
    s_add_u32 s68, s69, 2048
    buffer_load_dwordx4 v[24:27], v9, s[44:47], s68 offen sc1
    s_add_u32 s68, s69, 3072
    buffer_load_dwordx4 v[28:31], v9, s[44:47], s68 offen sc1
    s_lshl_b32 s69, s85, 12
    s_add_u32 s69, s69, s83
    s_add_u32 s68, s69, 0
    buffer_load_dwordx4 v[32:35], v9, s[44:47], s68 offen sc1
    s_add_u32 s68, s69, 1024
    buffer_load_dwordx4 v[36:39], v9, s[44:47], s68 offen sc1
    s_add_u32 s68, s69, 2048
    buffer_load_dwordx4 v[40:43], v9, s[44:47], s68 offen sc1
    s_add_u32 s68, s69, 3072
    buffer_load_dwordx4 v[44:47], v9, s[44:47], s68 offen sc1
    s_lshl_b32 s69, s86, 12
    s_add_u32 s69, s69, s83
    s_add_u32 s68, s69, 0
    buffer_load_dwordx4 v[48:51], v9, s[44:47], s68 offen sc1
    s_add_u32 s68, s69, 1024
    buffer_load_dwordx4 v[52:55], v9, s[44:47], s68 offen sc1
    s_add_u32 s68, s69, 2048
    buffer_load_dwordx4 v[56:59], v9, s[44:47], s68 offen sc1
    s_add_u32 s68, s69, 3072
    buffer_load_dwordx4 v[60:63], v9, s[44:47], s68 offen sc1
    s_lshl_b32 s69, s87, 12
    s_add_u32 s69, s69, s83
    s_add_u32 s68, s69, 0
    buffer_load_dwordx4 v[240:243], v9, s[44:47], s68 offen sc1
    s_add_u32 s68, s69, 1024
    buffer_load_dwordx4 v[244:247], v9, s[44:47], s68 offen sc1
    s_add_u32 s68, s69, 2048
    buffer_load_dwordx4 v[248:251], v9, s[44:47], s68 offen sc1
    s_add_u32 s68, s69, 3072
    buffer_load_dwordx4 v[252:255], v9, s[44:47], s68 offen sc1
    s_waitcnt vmcnt(12)
    v_mfma_f32_16x16x32_bf16 v[64:67], v[16:19], v[128:131], 0
    v_mfma_f32_16x16x32_bf16 v[68:71], v[16:19], v[132:135], 0
    v_mfma_f32_16x16x32_bf16 v[72:75], v[16:19], v[136:139], 0
    v_mfma_f32_16x16x32_bf16 v[76:79], v[16:19], v[140:143], 0
    v_mfma_f32_16x16x32_bf16 v[80:83], v[20:23], v[128:131], 0
    v_mfma_f32_16x16x32_bf16 v[84:87], v[20:23], v[132:135], 0
    v_mfma_f32_16x16x32_bf16 v[88:91], v[20:23], v[136:139], 0
    v_mfma_f32_16x16x32_bf16 v[92:95], v[20:23], v[140:143], 0
    v_mfma_f32_16x16x32_bf16 v[96:99], v[24:27], v[128:131], 0
    v_mfma_f32_16x16x32_bf16 v[100:103], v[24:27], v[132:135], 0
    v_mfma_f32_16x16x32_bf16 v[104:107], v[24:27], v[136:139], 0
    v_mfma_f32_16x16x32_bf16 v[108:111], v[24:27], v[140:143], 0
    v_mfma_f32_16x16x32_bf16 v[112:115], v[28:31], v[128:131], 0
    v_mfma_f32_16x16x32_bf16 v[116:119], v[28:31], v[132:135], 0
    v_mfma_f32_16x16x32_bf16 v[120:123], v[28:31], v[136:139], 0
    v_mfma_f32_16x16x32_bf16 v[124:127], v[28:31], v[140:143], 0
    s_lshl_b32 s69, s88, 12
    s_add_u32 s69, s69, s83
    s_add_u32 s68, s69, 0
    buffer_load_dwordx4 v[16:19], v9, s[44:47], s68 offen sc1
    s_add_u32 s68, s69, 1024
    buffer_load_dwordx4 v[20:23], v9, s[44:47], s68 offen sc1
    s_add_u32 s68, s69, 2048
    buffer_load_dwordx4 v[24:27], v9, s[44:47], s68 offen sc1
    s_add_u32 s68, s69, 3072
    buffer_load_dwordx4 v[28:31], v9, s[44:47], s68 offen sc1
    ds_read_b64_tr_b16 v[128:129], v5 offset:12288
    ds_read_b64_tr_b16 v[130:131], v5 offset:14336
    ds_read_b64_tr_b16 v[132:133], v6 offset:12288
    ds_read_b64_tr_b16 v[134:135], v6 offset:14336
    ds_read_b64_tr_b16 v[136:137], v7 offset:12288
    ds_read_b64_tr_b16 v[138:139], v7 offset:14336
    ds_read_b64_tr_b16 v[140:141], v8 offset:12288
    ds_read_b64_tr_b16 v[142:143], v8 offset:14336
    s_waitcnt vmcnt(12)
    v_mfma_f32_16x16x32_bf16 v[64:67], v[32:35], v[144:147], v[64:67]
    v_mfma_f32_16x16x32_bf16 v[68:71], v[32:35], v[148:151], v[68:71]
    v_mfma_f32_16x16x32_bf16 v[72:75], v[32:35], v[152:155], v[72:75]
    v_mfma_f32_16x16x32_bf16 v[76:79], v[32:35], v[156:159], v[76:79]
    v_mfma_f32_16x16x32_bf16 v[80:83], v[36:39], v[144:147], v[80:83]
    v_mfma_f32_16x16x32_bf16 v[84:87], v[36:39], v[148:151], v[84:87]
    v_mfma_f32_16x16x32_bf16 v[88:91], v[36:39], v[152:155], v[88:91]
    v_mfma_f32_16x16x32_bf16 v[92:95], v[36:39], v[156:159], v[92:95]
    v_mfma_f32_16x16x32_bf16 v[96:99], v[40:43], v[144:147], v[96:99]
    v_mfma_f32_16x16x32_bf16 v[100:103], v[40:43], v[148:151], v[100:103]
    v_mfma_f32_16x16x32_bf16 v[104:107], v[40:43], v[152:155], v[104:107]
    v_mfma_f32_16x16x32_bf16 v[108:111], v[40:43], v[156:159], v[108:111]
    v_mfma_f32_16x16x32_bf16 v[112:115], v[44:47], v[144:147], v[112:115]
    v_mfma_f32_16x16x32_bf16 v[116:119], v[44:47], v[148:151], v[116:119]
    v_mfma_f32_16x16x32_bf16 v[120:123], v[44:47], v[152:155], v[120:123]
    v_mfma_f32_16x16x32_bf16 v[124:127], v[44:47], v[156:159], v[124:127]
    s_lshl_b32 s69, s89, 12
    s_add_u32 s69, s69, s83
    s_add_u32 s68, s69, 0
    buffer_load_dwordx4 v[32:35], v9, s[44:47], s68 offen sc1
    s_add_u32 s68, s69, 1024
    buffer_load_dwordx4 v[36:39], v9, s[44:47], s68 offen sc1
    s_add_u32 s68, s69, 2048
    buffer_load_dwordx4 v[40:43], v9, s[44:47], s68 offen sc1
    s_add_u32 s68, s69, 3072
    buffer_load_dwordx4 v[44:47], v9, s[44:47], s68 offen sc1
    ds_read_b64_tr_b16 v[144:145], v5 offset:0
    ds_read_b64_tr_b16 v[146:147], v5 offset:2048
    ds_read_b64_tr_b16 v[148:149], v6 offset:0
    ds_read_b64_tr_b16 v[150:151], v6 offset:2048
    ds_read_b64_tr_b16 v[152:153], v7 offset:0
    ds_read_b64_tr_b16 v[154:155], v7 offset:2048
    ds_read_b64_tr_b16 v[156:157], v8 offset:0
    ds_read_b64_tr_b16 v[158:159], v8 offset:2048
    s_waitcnt lgkmcnt(8)
    s_waitcnt vmcnt(12)
    v_mfma_f32_16x16x32_bf16 v[64:67], v[48:51], v[160:163], v[64:67]
    v_mfma_f32_16x16x32_bf16 v[68:71], v[48:51], v[164:167], v[68:71]
    v_mfma_f32_16x16x32_bf16 v[72:75], v[48:51], v[168:171], v[72:75]
    v_mfma_f32_16x16x32_bf16 v[76:79], v[48:51], v[172:175], v[76:79]
    v_mfma_f32_16x16x32_bf16 v[80:83], v[52:55], v[160:163], v[80:83]
    v_mfma_f32_16x16x32_bf16 v[84:87], v[52:55], v[164:167], v[84:87]
    v_mfma_f32_16x16x32_bf16 v[88:91], v[52:55], v[168:171], v[88:91]
    v_mfma_f32_16x16x32_bf16 v[92:95], v[52:55], v[172:175], v[92:95]
    v_mfma_f32_16x16x32_bf16 v[96:99], v[56:59], v[160:163], v[96:99]
    v_mfma_f32_16x16x32_bf16 v[100:103], v[56:59], v[164:167], v[100:103]
    v_mfma_f32_16x16x32_bf16 v[104:107], v[56:59], v[168:171], v[104:107]
    v_mfma_f32_16x16x32_bf16 v[108:111], v[56:59], v[172:175], v[108:111]
    v_mfma_f32_16x16x32_bf16 v[112:115], v[60:63], v[160:163], v[112:115]
    v_mfma_f32_16x16x32_bf16 v[116:119], v[60:63], v[164:167], v[116:119]
    v_mfma_f32_16x16x32_bf16 v[120:123], v[60:63], v[168:171], v[120:123]
    v_mfma_f32_16x16x32_bf16 v[124:127], v[60:63], v[172:175], v[124:127]
    s_lshl_b32 s69, s90, 12
    s_add_u32 s69, s69, s83
    s_add_u32 s68, s69, 0
    buffer_load_dwordx4 v[48:51], v9, s[44:47], s68 offen sc1
    s_add_u32 s68, s69, 1024
    buffer_load_dwordx4 v[52:55], v9, s[44:47], s68 offen sc1
    s_add_u32 s68, s69, 2048
    buffer_load_dwordx4 v[56:59], v9, s[44:47], s68 offen sc1
    s_add_u32 s68, s69, 3072
    buffer_load_dwordx4 v[60:63], v9, s[44:47], s68 offen sc1
    ds_read_b64_tr_b16 v[160:161], v5 offset:4096
    ds_read_b64_tr_b16 v[162:163], v5 offset:6144
    ds_read_b64_tr_b16 v[164:165], v6 offset:4096
    ds_read_b64_tr_b16 v[166:167], v6 offset:6144
    ds_read_b64_tr_b16 v[168:169], v7 offset:4096
    ds_read_b64_tr_b16 v[170:171], v7 offset:6144
    ds_read_b64_tr_b16 v[172:173], v8 offset:4096
    ds_read_b64_tr_b16 v[174:175], v8 offset:6144
    s_waitcnt lgkmcnt(8)
    s_waitcnt vmcnt(12)
    v_mfma_f32_16x16x32_bf16 v[64:67], v[240:243], v[176:179], v[64:67]
    v_mfma_f32_16x16x32_bf16 v[68:71], v[240:243], v[180:183], v[68:71]
    v_mfma_f32_16x16x32_bf16 v[72:75], v[240:243], v[184:187], v[72:75]
    v_mfma_f32_16x16x32_bf16 v[76:79], v[240:243], v[188:191], v[76:79]
    v_mfma_f32_16x16x32_bf16 v[80:83], v[244:247], v[176:179], v[80:83]
    v_mfma_f32_16x16x32_bf16 v[84:87], v[244:247], v[180:183], v[84:87]
    v_mfma_f32_16x16x32_bf16 v[88:91], v[244:247], v[184:187], v[88:91]
    v_mfma_f32_16x16x32_bf16 v[92:95], v[244:247], v[188:191], v[92:95]
    v_mfma_f32_16x16x32_bf16 v[96:99], v[248:251], v[176:179], v[96:99]
    v_mfma_f32_16x16x32_bf16 v[100:103], v[248:251], v[180:183], v[100:103]
    v_mfma_f32_16x16x32_bf16 v[104:107], v[248:251], v[184:187], v[104:107]
    v_mfma_f32_16x16x32_bf16 v[108:111], v[248:251], v[188:191], v[108:111]
    v_mfma_f32_16x16x32_bf16 v[112:115], v[252:255], v[176:179], v[112:115]
    v_mfma_f32_16x16x32_bf16 v[116:119], v[252:255], v[180:183], v[116:119]
    v_mfma_f32_16x16x32_bf16 v[120:123], v[252:255], v[184:187], v[120:123]
    v_mfma_f32_16x16x32_bf16 v[124:127], v[252:255], v[188:191], v[124:127]
    s_lshl_b32 s69, s91, 12
    s_add_u32 s69, s69, s83
    s_add_u32 s68, s69, 0
    buffer_load_dwordx4 v[240:243], v9, s[44:47], s68 offen sc1
    s_add_u32 s68, s69, 1024
    buffer_load_dwordx4 v[244:247], v9, s[44:47], s68 offen sc1
    s_add_u32 s68, s69, 2048
    buffer_load_dwordx4 v[248:251], v9, s[44:47], s68 offen sc1
    s_add_u32 s68, s69, 3072
    buffer_load_dwordx4 v[252:255], v9, s[44:47], s68 offen sc1
    ds_read_b64_tr_b16 v[176:177], v5 offset:8192
    ds_read_b64_tr_b16 v[178:179], v5 offset:10240
    ds_read_b64_tr_b16 v[180:181], v6 offset:8192
    ds_read_b64_tr_b16 v[182:183], v6 offset:10240
    ds_read_b64_tr_b16 v[184:185], v7 offset:8192
    ds_read_b64_tr_b16 v[186:187], v7 offset:10240
    ds_read_b64_tr_b16 v[188:189], v8 offset:8192
    ds_read_b64_tr_b16 v[190:191], v8 offset:10240
    s_waitcnt lgkmcnt(8)
    s_waitcnt vmcnt(12)
    v_mfma_f32_16x16x32_bf16 v[64:67], v[16:19], v[192:195], v[64:67]
    v_mfma_f32_16x16x32_bf16 v[68:71], v[16:19], v[196:199], v[68:71]
    v_mfma_f32_16x16x32_bf16 v[72:75], v[16:19], v[200:203], v[72:75]
    v_mfma_f32_16x16x32_bf16 v[76:79], v[16:19], v[204:207], v[76:79]
    v_mfma_f32_16x16x32_bf16 v[80:83], v[20:23], v[192:195], v[80:83]
    v_mfma_f32_16x16x32_bf16 v[84:87], v[20:23], v[196:199], v[84:87]
    v_mfma_f32_16x16x32_bf16 v[88:91], v[20:23], v[200:203], v[88:91]
    v_mfma_f32_16x16x32_bf16 v[92:95], v[20:23], v[204:207], v[92:95]
    v_mfma_f32_16x16x32_bf16 v[96:99], v[24:27], v[192:195], v[96:99]
    v_mfma_f32_16x16x32_bf16 v[100:103], v[24:27], v[196:199], v[100:103]
    v_mfma_f32_16x16x32_bf16 v[104:107], v[24:27], v[200:203], v[104:107]
    v_mfma_f32_16x16x32_bf16 v[108:111], v[24:27], v[204:207], v[108:111]
    v_mfma_f32_16x16x32_bf16 v[112:115], v[28:31], v[192:195], v[112:115]
    v_mfma_f32_16x16x32_bf16 v[116:119], v[28:31], v[196:199], v[116:119]
    v_mfma_f32_16x16x32_bf16 v[120:123], v[28:31], v[200:203], v[120:123]
    v_mfma_f32_16x16x32_bf16 v[124:127], v[28:31], v[204:207], v[124:127]
    s_lshl_b32 s69, s92, 12
    s_add_u32 s69, s69, s83
    s_add_u32 s68, s69, 0
    buffer_load_dwordx4 v[16:19], v9, s[44:47], s68 offen sc1
    s_add_u32 s68, s69, 1024
    buffer_load_dwordx4 v[20:23], v9, s[44:47], s68 offen sc1
    s_add_u32 s68, s69, 2048
    buffer_load_dwordx4 v[24:27], v9, s[44:47], s68 offen sc1
    s_add_u32 s68, s69, 3072
    buffer_load_dwordx4 v[28:31], v9, s[44:47], s68 offen sc1
    s_waitcnt vmcnt(12)
    v_mfma_f32_16x16x32_bf16 v[64:67], v[32:35], v[208:211], v[64:67]
    v_mfma_f32_16x16x32_bf16 v[68:71], v[32:35], v[212:215], v[68:71]
    v_mfma_f32_16x16x32_bf16 v[72:75], v[32:35], v[216:219], v[72:75]
    v_mfma_f32_16x16x32_bf16 v[76:79], v[32:35], v[220:223], v[76:79]
    v_mfma_f32_16x16x32_bf16 v[80:83], v[36:39], v[208:211], v[80:83]
    v_mfma_f32_16x16x32_bf16 v[84:87], v[36:39], v[212:215], v[84:87]
    v_mfma_f32_16x16x32_bf16 v[88:91], v[36:39], v[216:219], v[88:91]
    v_mfma_f32_16x16x32_bf16 v[92:95], v[36:39], v[220:223], v[92:95]
    v_mfma_f32_16x16x32_bf16 v[96:99], v[40:43], v[208:211], v[96:99]
    v_mfma_f32_16x16x32_bf16 v[100:103], v[40:43], v[212:215], v[100:103]
    v_mfma_f32_16x16x32_bf16 v[104:107], v[40:43], v[216:219], v[104:107]
    v_mfma_f32_16x16x32_bf16 v[108:111], v[40:43], v[220:223], v[108:111]
    v_mfma_f32_16x16x32_bf16 v[112:115], v[44:47], v[208:211], v[112:115]
    v_mfma_f32_16x16x32_bf16 v[116:119], v[44:47], v[212:215], v[116:119]
    v_mfma_f32_16x16x32_bf16 v[120:123], v[44:47], v[216:219], v[120:123]
    v_mfma_f32_16x16x32_bf16 v[124:127], v[44:47], v[220:223], v[124:127]
    s_lshl_b32 s69, s93, 12
    s_add_u32 s69, s69, s83
    s_add_u32 s68, s69, 0
    buffer_load_dwordx4 v[32:35], v9, s[44:47], s68 offen sc1
    s_add_u32 s68, s69, 1024
    buffer_load_dwordx4 v[36:39], v9, s[44:47], s68 offen sc1
    s_add_u32 s68, s69, 2048
    buffer_load_dwordx4 v[40:43], v9, s[44:47], s68 offen sc1
    s_add_u32 s68, s69, 3072
    buffer_load_dwordx4 v[44:47], v9, s[44:47], s68 offen sc1
    v_mov_b32 v1, 152180
    v_mov_b32 v2, 1
    s_mov_b64 s[74:75], exec
    s_mov_b64 exec, 1
    ds_add_u32 v1, v2
    s_mov_b64 exec, s[74:75]
    s_waitcnt vmcnt(12)
    v_mfma_f32_16x16x32_bf16 v[64:67], v[48:51], v[224:227], v[64:67]
    v_mfma_f32_16x16x32_bf16 v[68:71], v[48:51], v[228:231], v[68:71]
    v_mfma_f32_16x16x32_bf16 v[72:75], v[48:51], v[232:235], v[72:75]
    v_mfma_f32_16x16x32_bf16 v[76:79], v[48:51], v[236:239], v[76:79]
    v_mfma_f32_16x16x32_bf16 v[80:83], v[52:55], v[224:227], v[80:83]
    v_mfma_f32_16x16x32_bf16 v[84:87], v[52:55], v[228:231], v[84:87]
    v_mfma_f32_16x16x32_bf16 v[88:91], v[52:55], v[232:235], v[88:91]
    v_mfma_f32_16x16x32_bf16 v[92:95], v[52:55], v[236:239], v[92:95]
    v_mfma_f32_16x16x32_bf16 v[96:99], v[56:59], v[224:227], v[96:99]
    v_mfma_f32_16x16x32_bf16 v[100:103], v[56:59], v[228:231], v[100:103]
    v_mfma_f32_16x16x32_bf16 v[104:107], v[56:59], v[232:235], v[104:107]
    v_mfma_f32_16x16x32_bf16 v[108:111], v[56:59], v[236:239], v[108:111]
    v_mfma_f32_16x16x32_bf16 v[112:115], v[60:63], v[224:227], v[112:115]
    v_mfma_f32_16x16x32_bf16 v[116:119], v[60:63], v[228:231], v[116:119]
    v_mfma_f32_16x16x32_bf16 v[120:123], v[60:63], v[232:235], v[120:123]
    v_mfma_f32_16x16x32_bf16 v[124:127], v[60:63], v[236:239], v[124:127]
    s_lshl_b32 s69, s94, 12
    s_add_u32 s69, s69, s83
    s_add_u32 s68, s69, 0
    buffer_load_dwordx4 v[48:51], v9, s[44:47], s68 offen sc1
    s_add_u32 s68, s69, 1024
    buffer_load_dwordx4 v[52:55], v9, s[44:47], s68 offen sc1
    s_add_u32 s68, s69, 2048
    buffer_load_dwordx4 v[56:59], v9, s[44:47], s68 offen sc1
    s_add_u32 s68, s69, 3072
    buffer_load_dwordx4 v[60:63], v9, s[44:47], s68 offen sc1
    s_waitcnt vmcnt(12)
    s_waitcnt lgkmcnt(0)
    v_mfma_f32_16x16x32_bf16 v[64:67], v[240:243], v[128:131], v[64:67]
    v_mfma_f32_16x16x32_bf16 v[68:71], v[240:243], v[132:135], v[68:71]
    v_mfma_f32_16x16x32_bf16 v[72:75], v[240:243], v[136:139], v[72:75]
    v_mfma_f32_16x16x32_bf16 v[76:79], v[240:243], v[140:143], v[76:79]
    v_mfma_f32_16x16x32_bf16 v[80:83], v[244:247], v[128:131], v[80:83]
    v_mfma_f32_16x16x32_bf16 v[84:87], v[244:247], v[132:135], v[84:87]
    v_mfma_f32_16x16x32_bf16 v[88:91], v[244:247], v[136:139], v[88:91]
    v_mfma_f32_16x16x32_bf16 v[92:95], v[244:247], v[140:143], v[92:95]
    v_mfma_f32_16x16x32_bf16 v[96:99], v[248:251], v[128:131], v[96:99]
    v_mfma_f32_16x16x32_bf16 v[100:103], v[248:251], v[132:135], v[100:103]
    v_mfma_f32_16x16x32_bf16 v[104:107], v[248:251], v[136:139], v[104:107]
    v_mfma_f32_16x16x32_bf16 v[108:111], v[248:251], v[140:143], v[108:111]
    v_mfma_f32_16x16x32_bf16 v[112:115], v[252:255], v[128:131], v[112:115]
    v_mfma_f32_16x16x32_bf16 v[116:119], v[252:255], v[132:135], v[116:119]
    v_mfma_f32_16x16x32_bf16 v[120:123], v[252:255], v[136:139], v[120:123]
    v_mfma_f32_16x16x32_bf16 v[124:127], v[252:255], v[140:143], v[124:127]
    s_waitcnt vmcnt(8)
    s_waitcnt lgkmcnt(0)
    v_mfma_f32_16x16x32_bf16 v[64:67], v[16:19], v[144:147], v[64:67]
    v_mfma_f32_16x16x32_bf16 v[68:71], v[16:19], v[148:151], v[68:71]
    v_mfma_f32_16x16x32_bf16 v[72:75], v[16:19], v[152:155], v[72:75]
    v_mfma_f32_16x16x32_bf16 v[76:79], v[16:19], v[156:159], v[76:79]
    v_mfma_f32_16x16x32_bf16 v[80:83], v[20:23], v[144:147], v[80:83]
    v_mfma_f32_16x16x32_bf16 v[84:87], v[20:23], v[148:151], v[84:87]
    v_mfma_f32_16x16x32_bf16 v[88:91], v[20:23], v[152:155], v[88:91]
    v_mfma_f32_16x16x32_bf16 v[92:95], v[20:23], v[156:159], v[92:95]
    v_mfma_f32_16x16x32_bf16 v[96:99], v[24:27], v[144:147], v[96:99]
    v_mfma_f32_16x16x32_bf16 v[100:103], v[24:27], v[148:151], v[100:103]
    v_mfma_f32_16x16x32_bf16 v[104:107], v[24:27], v[152:155], v[104:107]
    v_mfma_f32_16x16x32_bf16 v[108:111], v[24:27], v[156:159], v[108:111]
    v_mfma_f32_16x16x32_bf16 v[112:115], v[28:31], v[144:147], v[112:115]
    v_mfma_f32_16x16x32_bf16 v[116:119], v[28:31], v[148:151], v[116:119]
    v_mfma_f32_16x16x32_bf16 v[120:123], v[28:31], v[152:155], v[120:123]
    v_mfma_f32_16x16x32_bf16 v[124:127], v[28:31], v[156:159], v[124:127]
    s_waitcnt vmcnt(4)
    s_waitcnt lgkmcnt(0)
    v_mfma_f32_16x16x32_bf16 v[64:67], v[32:35], v[160:163], v[64:67]
    v_mfma_f32_16x16x32_bf16 v[68:71], v[32:35], v[164:167], v[68:71]
    v_mfma_f32_16x16x32_bf16 v[72:75], v[32:35], v[168:171], v[72:75]
    v_mfma_f32_16x16x32_bf16 v[76:79], v[32:35], v[172:175], v[76:79]
    v_mfma_f32_16x16x32_bf16 v[80:83], v[36:39], v[160:163], v[80:83]
    v_mfma_f32_16x16x32_bf16 v[84:87], v[36:39], v[164:167], v[84:87]
    v_mfma_f32_16x16x32_bf16 v[88:91], v[36:39], v[168:171], v[88:91]
    v_mfma_f32_16x16x32_bf16 v[92:95], v[36:39], v[172:175], v[92:95]
    v_mfma_f32_16x16x32_bf16 v[96:99], v[40:43], v[160:163], v[96:99]
    v_mfma_f32_16x16x32_bf16 v[100:103], v[40:43], v[164:167], v[100:103]
    v_mfma_f32_16x16x32_bf16 v[104:107], v[40:43], v[168:171], v[104:107]
    v_mfma_f32_16x16x32_bf16 v[108:111], v[40:43], v[172:175], v[108:111]
    v_mfma_f32_16x16x32_bf16 v[112:115], v[44:47], v[160:163], v[112:115]
    v_mfma_f32_16x16x32_bf16 v[116:119], v[44:47], v[164:167], v[116:119]
    v_mfma_f32_16x16x32_bf16 v[120:123], v[44:47], v[168:171], v[120:123]
    v_mfma_f32_16x16x32_bf16 v[124:127], v[44:47], v[172:175], v[124:127]
    s_cmp_lt_u32 s95, 11
    s_cbranch_scc1 Lno11_20
    s_waitcnt vmcnt(0)
    s_waitcnt lgkmcnt(0)
    v_mfma_f32_16x16x32_bf16 v[64:67], v[48:51], v[176:179], v[64:67]
    v_mfma_f32_16x16x32_bf16 v[68:71], v[48:51], v[180:183], v[68:71]
    v_mfma_f32_16x16x32_bf16 v[72:75], v[48:51], v[184:187], v[72:75]
    v_mfma_f32_16x16x32_bf16 v[76:79], v[48:51], v[188:191], v[76:79]
    v_mfma_f32_16x16x32_bf16 v[80:83], v[52:55], v[176:179], v[80:83]
    v_mfma_f32_16x16x32_bf16 v[84:87], v[52:55], v[180:183], v[84:87]
    v_mfma_f32_16x16x32_bf16 v[88:91], v[52:55], v[184:187], v[88:91]
    v_mfma_f32_16x16x32_bf16 v[92:95], v[52:55], v[188:191], v[92:95]
    v_mfma_f32_16x16x32_bf16 v[96:99], v[56:59], v[176:179], v[96:99]
    v_mfma_f32_16x16x32_bf16 v[100:103], v[56:59], v[180:183], v[100:103]
    v_mfma_f32_16x16x32_bf16 v[104:107], v[56:59], v[184:187], v[104:107]
    v_mfma_f32_16x16x32_bf16 v[108:111], v[56:59], v[188:191], v[108:111]
    v_mfma_f32_16x16x32_bf16 v[112:115], v[60:63], v[176:179], v[112:115]
    v_mfma_f32_16x16x32_bf16 v[116:119], v[60:63], v[180:183], v[116:119]
    v_mfma_f32_16x16x32_bf16 v[120:123], v[60:63], v[184:187], v[120:123]
    v_mfma_f32_16x16x32_bf16 v[124:127], v[60:63], v[188:191], v[124:127]
Lno11_20:
    s_lshl_b32 s62, s3, 14
    s_add_u32 m0, s62, 2048
    s_nop 0
    ds_write_addtid_b32 v64 offset:32768
    ds_write_addtid_b32 v65 offset:33024
    ds_write_addtid_b32 v66 offset:33280
    ds_write_addtid_b32 v67 offset:33536
    ds_write_addtid_b32 v68 offset:33792
    ds_write_addtid_b32 v69 offset:34048
    ds_write_addtid_b32 v70 offset:34304
    ds_write_addtid_b32 v71 offset:34560
    ds_write_addtid_b32 v72 offset:34816
    ds_write_addtid_b32 v73 offset:35072
    ds_write_addtid_b32 v74 offset:35328
    ds_write_addtid_b32 v75 offset:35584
    ds_write_addtid_b32 v76 offset:35840
    ds_write_addtid_b32 v77 offset:36096
    ds_write_addtid_b32 v78 offset:36352
    ds_write_addtid_b32 v79 offset:36608
    ds_write_addtid_b32 v80 offset:36864
    ds_write_addtid_b32 v81 offset:37120
    ds_write_addtid_b32 v82 offset:37376
    ds_write_addtid_b32 v83 offset:37632
    ds_write_addtid_b32 v84 offset:37888
    ds_write_addtid_b32 v85 offset:38144
    ds_write_addtid_b32 v86 offset:38400
    ds_write_addtid_b32 v87 offset:38656
    ds_write_addtid_b32 v88 offset:38912
    ds_write_addtid_b32 v89 offset:39168
    ds_write_addtid_b32 v90 offset:39424
    ds_write_addtid_b32 v91 offset:39680
    ds_write_addtid_b32 v92 offset:39936
    ds_write_addtid_b32 v93 offset:40192
    ds_write_addtid_b32 v94 offset:40448
    ds_write_addtid_b32 v95 offset:40704
    ds_write_addtid_b32 v96 offset:40960
    ds_write_addtid_b32 v97 offset:41216
    ds_write_addtid_b32 v98 offset:41472
    ds_write_addtid_b32 v99 offset:41728
    ds_write_addtid_b32 v100 offset:41984
    ds_write_addtid_b32 v101 offset:42240
    ds_write_addtid_b32 v102 offset:42496
    ds_write_addtid_b32 v103 offset:42752
    ds_write_addtid_b32 v104 offset:43008
    ds_write_addtid_b32 v105 offset:43264
    ds_write_addtid_b32 v106 offset:43520
    ds_write_addtid_b32 v107 offset:43776
    ds_write_addtid_b32 v108 offset:44032
    ds_write_addtid_b32 v109 offset:44288
    ds_write_addtid_b32 v110 offset:44544
    ds_write_addtid_b32 v111 offset:44800
    ds_write_addtid_b32 v112 offset:45056
    ds_write_addtid_b32 v113 offset:45312
    ds_write_addtid_b32 v114 offset:45568
    ds_write_addtid_b32 v115 offset:45824
    ds_write_addtid_b32 v116 offset:46080
    ds_write_addtid_b32 v117 offset:46336
    ds_write_addtid_b32 v118 offset:46592
    ds_write_addtid_b32 v119 offset:46848
    ds_write_addtid_b32 v120 offset:47104
    ds_write_addtid_b32 v121 offset:47360
    ds_write_addtid_b32 v122 offset:47616
    ds_write_addtid_b32 v123 offset:47872
    ds_write_addtid_b32 v124 offset:48128
    ds_write_addtid_b32 v125 offset:48384
    ds_write_addtid_b32 v126 offset:48640
    ds_write_addtid_b32 v127 offset:48896
    s_waitcnt lgkmcnt(0)
    s_branch L_tail
L_helper:
    s_mov_b32 s36, s4
    s_and_b32 s37, s5, 0xffff
    s_mov_b32 s38, 2097152
    s_mov_b32 s39, 0x20000
    s_mov_b32 s40, s20
    s_and_b32 s41, s21, 0xffff
    s_mov_b32 s42, 1409024
    s_mov_b32 s43, 0x20000
    s_mov_b32 s44, s32
    s_and_b32 s45, s33, 0xffff
    s_mov_b32 s46, 16777216
    s_mov_b32 s47, 0x20000
    s_mov_b32 s48, s28
    s_and_b32 s49, s29, 0xffff
    s_mov_b32 s50, 2097152
    s_mov_b32 s51, 0x20000
    s_mul_i32 s78, s61, 8704
    s_add_u32 s78, s78, 0
    s_cmp_lg_u32 s2, 0
    s_cbranch_scc1 Lnn_21
    s_cmp_lg_u32 s3, 4
    s_cbranch_scc1 Lnn_21
    s_memrealtime s[62:63]
    s_waitcnt lgkmcnt(0)
    s_or_b32 s62, s62, 1
    v_mov_b32 v1, s62
    v_mov_b32 v2, 0
    s_mov_b64 s[74:75], exec
    s_mov_b64 exec, 1
    global_store_dword v2, v1, s[30:31] sc1
    s_mov_b64 exec, s[74:75]
Lnn_21:
    v_lshl_add_u32 v20, v0, 2, s78
    v_and_b32 v13, 31, v0
    v_lshrrev_b32 v14, 5, v0
    v_mul_u32_u24 v21, 272, v13
    v_lshl_add_u32 v21, v14, 4, v21
    v_add_u32 v21, s78, v21
    v_lshlrev_b32 v22, 2, v13
    v_lshl_add_u32 v22, v14, 9, v22
    v_add_u32 v22, s78, v22
    v_mov_b32 v23, s78
    v_add_u32 v23, 8192, v23
    v_add_u32 v236, 0, v0
    v_mul_u32_u24 v237, 2731, v236
    v_lshrrev_b32 v237, 16, v237
    v_mul_u32_u24 v238, 24, v237
    v_sub_u32 v238, v236, v238
    v_lshrrev_b32 v239, 1, v237
    v_and_b32 v239, 3, v239
    v_lshlrev_b32 v239, 1, v239
    v_xor_b32 v238, v238, v239
    v_lshrrev_b32 v239, 2, v237
    v_lshlrev_b32 v239, 3, v239
    v_and_b32 v237, 3, v237
    v_add_u32 v237, v237, v239
    v_mul_u32_u24 v237, 2752, v237
    v_lshl_add_u32 v232, v238, 4, v237
    v_add_u32 v236, 64, v0
    v_mul_u32_u24 v237, 2731, v236
    v_lshrrev_b32 v237, 16, v237
    v_mul_u32_u24 v238, 24, v237
    v_sub_u32 v238, v236, v238
    v_lshrrev_b32 v239, 1, v237
    v_and_b32 v239, 3, v239
    v_lshlrev_b32 v239, 1, v239
    v_xor_b32 v238, v238, v239
    v_lshrrev_b32 v239, 2, v237
    v_lshlrev_b32 v239, 3, v239
    v_and_b32 v237, 3, v237
    v_add_u32 v237, v237, v239
    v_mul_u32_u24 v237, 2752, v237
    v_lshl_add_u32 v233, v238, 4, v237
    v_add_u32 v236, 128, v0
    v_mul_u32_u24 v237, 2731, v236
    v_lshrrev_b32 v237, 16, v237
    v_mul_u32_u24 v238, 24, v237
    v_sub_u32 v238, v236, v238
    v_lshrrev_b32 v239, 1, v237
    v_and_b32 v239, 3, v239
    v_lshlrev_b32 v239, 1, v239
    v_xor_b32 v238, v238, v239
    v_lshrrev_b32 v239, 2, v237
    v_lshlrev_b32 v239, 3, v239
    v_and_b32 v237, 3, v237
    v_add_u32 v237, v237, v239
    v_mul_u32_u24 v237, 2752, v237
    v_lshl_add_u32 v234, v238, 4, v237
    s_waitcnt vmcnt(0)
    s_mov_b32 m0, s78
    s_mov_b32 s79, 0x3fb8aa3b
    s_mov_b32 s80, 0x32a57060
    s_mov_b32 s81, 0x3f317218
    v_lshlrev_b32 v8, 16, v8
    v_lshlrev_b32 v9, 16, v9
    v_lshlrev_b32 v10, 16, v10
    v_lshlrev_b32 v11, 16, v11
    v_lshlrev_b32 v12, 16, v12
    v_mul_f32 v80, s79, v12
    v_mul_f32 v83, s79, v8
    v_fma_f32 v81, v12, s79, -v80
    v_fma_f32 v84, v8, s79, -v83
    v_exp_f32 v82, v80
    v_exp_f32 v85, v83
    v_fma_f32 v81, v12, s80, v81
    v_fma_f32 v84, v8, s80, v84
    v_mul_f32 v81, s81, v81
    v_mul_f32 v84, s81, v84
    v_fma_f32 v82, v82, v81, v82
    v_fma_f32 v85, v85, v84, v85
    v_cvt_pk_bf16_f32 v12, v82, v82
    v_cvt_pk_bf16_f32 v8, v85, v85
    v_and_b32 v12, 0xffff0000, v12
    v_and_b32 v8, 0xffff0000, v8
    v_mul_f32 v8, v8, v12
    v_mul_f32 v9, v9, v12
    v_mul_f32 v10, v10, v12
    v_mul_f32 v11, v11, v12
    v_mul_f32 v8, 0xbfb8aa3b, v8
    v_mul_f32 v9, 0x3e22f983, v9
    v_mul_f32 v80, 0x3f800000, v8
    v_mul_f32 v82, 0x40000000, v8
    v_mul_f32 v84, 0x42000000, v8
    v_mul_f32 v86, 0x42800000, v8
    v_mul_f32 v81, 0x3f800000, v9
    v_mul_f32 v83, 0x40000000, v9
    v_mul_f32 v85, 0xc2000000, v9
    v_mul_f32 v87, 0xc2800000, v9
    v_fract_f32 v81, v81
    v_fract_f32 v83, v83
    v_fract_f32 v85, v85
    v_fract_f32 v87, v87
    v_exp_f32 v80, v80
    v_exp_f32 v82, v82
    v_exp_f32 v84, v84
    v_exp_f32 v86, v86
    v_cos_f32 v26, v81
    v_cos_f32 v28, v83
    v_cos_f32 v32, v85
    v_cos_f32 v36, v87
    v_sin_f32 v27, v81
    v_sin_f32 v29, v83
    v_sin_f32 v33, v85
    v_sin_f32 v37, v87
    v_mul_f32 v26, v26, v80
    v_mul_f32 v28, v28, v82
    v_mul_f32 v32, v32, v84
    v_mul_f32 v36, v36, v86
    v_mul_f32 v27, v27, v80
    v_mul_f32 v29, v29, v82
    v_mul_f32 v33, v33, v84
    v_mul_f32 v37, v37, v86
    v_mov_b32 v30, v29
    v_mov_b32 v34, v33
    v_mov_b32 v38, v37
    v_mov_b32 v24, 1.0
    v_mov_b32 v25, 0
    v_add_f32 v40, v10, v10
    v_mul_f32 v41, -2.0, v11
    v_add_f32 v42, v10, v10
    v_mul_f32 v43, -2.0, v11
    v_pk_mul_f32 v[44:45], v[42:43], v[32:33] op_sel:[0,0] op_sel_hi:[1,0]
    v_pk_fma_f32 v[42:43], v[42:43], v[34:35], v[44:45] op_sel:[1,0,0] op_sel_hi:[0,0,1] neg_lo:[1,0,0]
    s_mov_b32 m0, s78
    v_pk_mul_f32 v[44:45], v[24:25], v[28:29] op_sel:[0,0] op_sel_hi:[1,0]
    v_pk_mul_f32 v[46:47], v[26:27], v[28:29] op_sel:[0,0] op_sel_hi:[1,0]
    v_cvt_pk_bf16_f32 v16, v24, v25
    v_cvt_pk_bf16_f32 v17, v26, v27
    v_pk_fma_f32 v[24:25], v[24:25], v[30:31], v[44:45] op_sel:[1,0,0] op_sel_hi:[0,0,1] neg_lo:[1,0,0]
    v_pk_fma_f32 v[26:27], v[26:27], v[30:31], v[46:47] op_sel:[1,0,0] op_sel_hi:[0,0,1] neg_lo:[1,0,0]
    ds_write_addtid_b32 v16 offset:0
    ds_write_addtid_b32 v17 offset:272
    s_mov_b32 m0, s78
    v_pk_mul_f32 v[44:45], v[24:25], v[28:29] op_sel:[0,0] op_sel_hi:[1,0]
    v_pk_mul_f32 v[46:47], v[26:27], v[28:29] op_sel:[0,0] op_sel_hi:[1,0]
    v_cvt_pk_bf16_f32 v18, v24, v25
    v_cvt_pk_bf16_f32 v19, v26, v27
    v_pk_fma_f32 v[24:25], v[24:25], v[30:31], v[44:45] op_sel:[1,0,0] op_sel_hi:[0,0,1] neg_lo:[1,0,0]
    v_pk_fma_f32 v[26:27], v[26:27], v[30:31], v[46:47] op_sel:[1,0,0] op_sel_hi:[0,0,1] neg_lo:[1,0,0]
    ds_write_addtid_b32 v18 offset:544
    ds_write_addtid_b32 v19 offset:816
    s_mov_b32 m0, s78
    v_pk_mul_f32 v[44:45], v[24:25], v[28:29] op_sel:[0,0] op_sel_hi:[1,0]
    v_pk_mul_f32 v[46:47], v[26:27], v[28:29] op_sel:[0,0] op_sel_hi:[1,0]
    v_cvt_pk_bf16_f32 v16, v24, v25
    v_cvt_pk_bf16_f32 v17, v26, v27
    v_pk_fma_f32 v[24:25], v[24:25], v[30:31], v[44:45] op_sel:[1,0,0] op_sel_hi:[0,0,1] neg_lo:[1,0,0]
    v_pk_fma_f32 v[26:27], v[26:27], v[30:31], v[46:47] op_sel:[1,0,0] op_sel_hi:[0,0,1] neg_lo:[1,0,0]
    ds_write_addtid_b32 v16 offset:1088
    ds_write_addtid_b32 v17 offset:1360
    s_mov_b32 m0, s78
    v_pk_mul_f32 v[44:45], v[24:25], v[28:29] op_sel:[0,0] op_sel_hi:[1,0]
    v_pk_mul_f32 v[46:47], v[26:27], v[28:29] op_sel:[0,0] op_sel_hi:[1,0]
    v_cvt_pk_bf16_f32 v18, v24, v25
    v_cvt_pk_bf16_f32 v19, v26, v27
    v_pk_fma_f32 v[24:25], v[24:25], v[30:31], v[44:45] op_sel:[1,0,0] op_sel_hi:[0,0,1] neg_lo:[1,0,0]
    v_pk_fma_f32 v[26:27], v[26:27], v[30:31], v[46:47] op_sel:[1,0,0] op_sel_hi:[0,0,1] neg_lo:[1,0,0]
    ds_write_addtid_b32 v18 offset:1632
    ds_write_addtid_b32 v19 offset:1904
    s_mov_b32 m0, s78
    v_pk_mul_f32 v[44:45], v[24:25], v[28:29] op_sel:[0,0] op_sel_hi:[1,0]
    v_pk_mul_f32 v[46:47], v[26:27], v[28:29] op_sel:[0,0] op_sel_hi:[1,0]
    v_cvt_pk_bf16_f32 v16, v24, v25
    v_cvt_pk_bf16_f32 v17, v26, v27
    v_pk_fma_f32 v[24:25], v[24:25], v[30:31], v[44:45] op_sel:[1,0,0] op_sel_hi:[0,0,1] neg_lo:[1,0,0]
    v_pk_fma_f32 v[26:27], v[26:27], v[30:31], v[46:47] op_sel:[1,0,0] op_sel_hi:[0,0,1] neg_lo:[1,0,0]
    ds_write_addtid_b32 v16 offset:2176
    ds_write_addtid_b32 v17 offset:2448
    s_mov_b32 m0, s78
    v_pk_mul_f32 v[44:45], v[24:25], v[28:29] op_sel:[0,0] op_sel_hi:[1,0]
    v_pk_mul_f32 v[46:47], v[26:27], v[28:29] op_sel:[0,0] op_sel_hi:[1,0]
    v_cvt_pk_bf16_f32 v18, v24, v25
    v_cvt_pk_bf16_f32 v19, v26, v27
    v_pk_fma_f32 v[24:25], v[24:25], v[30:31], v[44:45] op_sel:[1,0,0] op_sel_hi:[0,0,1] neg_lo:[1,0,0]
    v_pk_fma_f32 v[26:27], v[26:27], v[30:31], v[46:47] op_sel:[1,0,0] op_sel_hi:[0,0,1] neg_lo:[1,0,0]
    ds_write_addtid_b32 v18 offset:2720
    ds_write_addtid_b32 v19 offset:2992
    s_mov_b32 m0, s78
    v_pk_mul_f32 v[44:45], v[24:25], v[28:29] op_sel:[0,0] op_sel_hi:[1,0]
    v_pk_mul_f32 v[46:47], v[26:27], v[28:29] op_sel:[0,0] op_sel_hi:[1,0]
    v_cvt_pk_bf16_f32 v16, v24, v25
    v_cvt_pk_bf16_f32 v17, v26, v27
    v_pk_fma_f32 v[24:25], v[24:25], v[30:31], v[44:45] op_sel:[1,0,0] op_sel_hi:[0,0,1] neg_lo:[1,0,0]
    v_pk_fma_f32 v[26:27], v[26:27], v[30:31], v[46:47] op_sel:[1,0,0] op_sel_hi:[0,0,1] neg_lo:[1,0,0]
    ds_write_addtid_b32 v16 offset:3264
    ds_write_addtid_b32 v17 offset:3536
    s_mov_b32 m0, s78
    v_pk_mul_f32 v[44:45], v[24:25], v[28:29] op_sel:[0,0] op_sel_hi:[1,0]
    v_pk_mul_f32 v[46:47], v[26:27], v[28:29] op_sel:[0,0] op_sel_hi:[1,0]
    v_cvt_pk_bf16_f32 v18, v24, v25
    v_cvt_pk_bf16_f32 v19, v26, v27
    v_pk_fma_f32 v[24:25], v[24:25], v[30:31], v[44:45] op_sel:[1,0,0] op_sel_hi:[0,0,1] neg_lo:[1,0,0]
    v_pk_fma_f32 v[26:27], v[26:27], v[30:31], v[46:47] op_sel:[1,0,0] op_sel_hi:[0,0,1] neg_lo:[1,0,0]
    ds_write_addtid_b32 v18 offset:3808
    ds_write_addtid_b32 v19 offset:4080
    s_mov_b32 m0, s78
    v_pk_mul_f32 v[44:45], v[24:25], v[28:29] op_sel:[0,0] op_sel_hi:[1,0]
    v_pk_mul_f32 v[46:47], v[26:27], v[28:29] op_sel:[0,0] op_sel_hi:[1,0]
    v_cvt_pk_bf16_f32 v16, v24, v25
    v_cvt_pk_bf16_f32 v17, v26, v27
    v_pk_fma_f32 v[24:25], v[24:25], v[30:31], v[44:45] op_sel:[1,0,0] op_sel_hi:[0,0,1] neg_lo:[1,0,0]
    v_pk_fma_f32 v[26:27], v[26:27], v[30:31], v[46:47] op_sel:[1,0,0] op_sel_hi:[0,0,1] neg_lo:[1,0,0]
    ds_write_addtid_b32 v16 offset:4352
    ds_write_addtid_b32 v17 offset:4624
    s_mov_b32 m0, s78
    v_pk_mul_f32 v[44:45], v[24:25], v[28:29] op_sel:[0,0] op_sel_hi:[1,0]
    v_pk_mul_f32 v[46:47], v[26:27], v[28:29] op_sel:[0,0] op_sel_hi:[1,0]
    v_cvt_pk_bf16_f32 v18, v24, v25
    v_cvt_pk_bf16_f32 v19, v26, v27
    v_pk_fma_f32 v[24:25], v[24:25], v[30:31], v[44:45] op_sel:[1,0,0] op_sel_hi:[0,0,1] neg_lo:[1,0,0]
    v_pk_fma_f32 v[26:27], v[26:27], v[30:31], v[46:47] op_sel:[1,0,0] op_sel_hi:[0,0,1] neg_lo:[1,0,0]
    ds_write_addtid_b32 v18 offset:4896
    ds_write_addtid_b32 v19 offset:5168
    s_mov_b32 m0, s78
    v_pk_mul_f32 v[44:45], v[24:25], v[28:29] op_sel:[0,0] op_sel_hi:[1,0]
    v_pk_mul_f32 v[46:47], v[26:27], v[28:29] op_sel:[0,0] op_sel_hi:[1,0]
    v_cvt_pk_bf16_f32 v16, v24, v25
    v_cvt_pk_bf16_f32 v17, v26, v27
    v_pk_fma_f32 v[24:25], v[24:25], v[30:31], v[44:45] op_sel:[1,0,0] op_sel_hi:[0,0,1] neg_lo:[1,0,0]
    v_pk_fma_f32 v[26:27], v[26:27], v[30:31], v[46:47] op_sel:[1,0,0] op_sel_hi:[0,0,1] neg_lo:[1,0,0]
    ds_write_addtid_b32 v16 offset:5440
    ds_write_addtid_b32 v17 offset:5712
    s_mov_b32 m0, s78
    v_pk_mul_f32 v[44:45], v[24:25], v[28:29] op_sel:[0,0] op_sel_hi:[1,0]
    v_pk_mul_f32 v[46:47], v[26:27], v[28:29] op_sel:[0,0] op_sel_hi:[1,0]
    v_cvt_pk_bf16_f32 v18, v24, v25
    v_cvt_pk_bf16_f32 v19, v26, v27
    v_pk_fma_f32 v[24:25], v[24:25], v[30:31], v[44:45] op_sel:[1,0,0] op_sel_hi:[0,0,1] neg_lo:[1,0,0]
    v_pk_fma_f32 v[26:27], v[26:27], v[30:31], v[46:47] op_sel:[1,0,0] op_sel_hi:[0,0,1] neg_lo:[1,0,0]
    ds_write_addtid_b32 v18 offset:5984
    ds_write_addtid_b32 v19 offset:6256
    s_mov_b32 m0, s78
    v_pk_mul_f32 v[44:45], v[24:25], v[28:29] op_sel:[0,0] op_sel_hi:[1,0]
    v_pk_mul_f32 v[46:47], v[26:27], v[28:29] op_sel:[0,0] op_sel_hi:[1,0]
    v_cvt_pk_bf16_f32 v16, v24, v25
    v_cvt_pk_bf16_f32 v17, v26, v27
    v_pk_fma_f32 v[24:25], v[24:25], v[30:31], v[44:45] op_sel:[1,0,0] op_sel_hi:[0,0,1] neg_lo:[1,0,0]
    v_pk_fma_f32 v[26:27], v[26:27], v[30:31], v[46:47] op_sel:[1,0,0] op_sel_hi:[0,0,1] neg_lo:[1,0,0]
    ds_write_addtid_b32 v16 offset:6528
    ds_write_addtid_b32 v17 offset:6800
    s_mov_b32 m0, s78
    v_pk_mul_f32 v[44:45], v[24:25], v[28:29] op_sel:[0,0] op_sel_hi:[1,0]
    v_pk_mul_f32 v[46:47], v[26:27], v[28:29] op_sel:[0,0] op_sel_hi:[1,0]
    v_cvt_pk_bf16_f32 v18, v24, v25
    v_cvt_pk_bf16_f32 v19, v26, v27
    v_pk_fma_f32 v[24:25], v[24:25], v[30:31], v[44:45] op_sel:[1,0,0] op_sel_hi:[0,0,1] neg_lo:[1,0,0]
    v_pk_fma_f32 v[26:27], v[26:27], v[30:31], v[46:47] op_sel:[1,0,0] op_sel_hi:[0,0,1] neg_lo:[1,0,0]
    ds_write_addtid_b32 v18 offset:7072
    ds_write_addtid_b32 v19 offset:7344
    s_mov_b32 m0, s78
    v_pk_mul_f32 v[44:45], v[24:25], v[28:29] op_sel:[0,0] op_sel_hi:[1,0]
    v_pk_mul_f32 v[46:47], v[26:27], v[28:29] op_sel:[0,0] op_sel_hi:[1,0]
    v_cvt_pk_bf16_f32 v16, v24, v25
    v_cvt_pk_bf16_f32 v17, v26, v27
    v_pk_fma_f32 v[24:25], v[24:25], v[30:31], v[44:45] op_sel:[1,0,0] op_sel_hi:[0,0,1] neg_lo:[1,0,0]
    v_pk_fma_f32 v[26:27], v[26:27], v[30:31], v[46:47] op_sel:[1,0,0] op_sel_hi:[0,0,1] neg_lo:[1,0,0]
    ds_write_addtid_b32 v16 offset:7616
    ds_write_addtid_b32 v17 offset:7888
    s_mov_b32 m0, s78
    v_pk_mul_f32 v[44:45], v[24:25], v[28:29] op_sel:[0,0] op_sel_hi:[1,0]
    v_cvt_pk_bf16_f32 v18, v24, v25
    v_cvt_pk_bf16_f32 v19, v26, v27
    v_pk_fma_f32 v[24:25], v[24:25], v[30:31], v[44:45] op_sel:[1,0,0] op_sel_hi:[0,0,1] neg_lo:[1,0,0]
    ds_write_addtid_b32 v18 offset:8160
    ds_write_addtid_b32 v19 offset:8432
    s_mov_b32 m0, s78
    s_waitcnt lgkmcnt(0)
    ds_read_b128 v[48:51], v21 offset:0
    ds_read_b128 v[52:55], v21 offset:32
    ds_read_b128 v[56:59], v21 offset:64
    ds_read_b128 v[60:63], v21 offset:96
    ds_read_b128 v[64:67], v21 offset:128
    ds_read_b128 v[68:71], v21 offset:160
    ds_read_b128 v[72:75], v21 offset:192
    ds_read_b128 v[76:79], v21 offset:224
    s_waitcnt lgkmcnt(0)
    s_mov_b32 m0, s78
    v_pk_mul_f32 v[44:45], v[40:41], v[36:37] op_sel:[0,0] op_sel_hi:[1,0]
    v_pk_mul_f32 v[46:47], v[42:43], v[36:37] op_sel:[0,0] op_sel_hi:[1,0]
    v_cvt_pk_bf16_f32 v16, v40, v41
    v_cvt_pk_bf16_f32 v17, v42, v43
    v_pk_fma_f32 v[40:41], v[40:41], v[38:39], v[44:45] op_sel:[1,0,0] op_sel_hi:[0,0,1] neg_lo:[1,0,0]
    v_pk_fma_f32 v[42:43], v[42:43], v[38:39], v[46:47] op_sel:[1,0,0] op_sel_hi:[0,0,1] neg_lo:[1,0,0]
    ds_write_addtid_b32 v16 offset:0
    ds_write_addtid_b32 v17 offset:272
    s_mov_b32 m0, s78
    v_pk_mul_f32 v[44:45], v[40:41], v[36:37] op_sel:[0,0] op_sel_hi:[1,0]
    v_pk_mul_f32 v[46:47], v[42:43], v[36:37] op_sel:[0,0] op_sel_hi:[1,0]
    v_cvt_pk_bf16_f32 v18, v40, v41
    v_cvt_pk_bf16_f32 v19, v42, v43
    v_pk_fma_f32 v[40:41], v[40:41], v[38:39], v[44:45] op_sel:[1,0,0] op_sel_hi:[0,0,1] neg_lo:[1,0,0]
    v_pk_fma_f32 v[42:43], v[42:43], v[38:39], v[46:47] op_sel:[1,0,0] op_sel_hi:[0,0,1] neg_lo:[1,0,0]
    ds_write_addtid_b32 v18 offset:544
    ds_write_addtid_b32 v19 offset:816
    s_mov_b32 m0, s78
    v_pk_mul_f32 v[44:45], v[40:41], v[36:37] op_sel:[0,0] op_sel_hi:[1,0]
    v_pk_mul_f32 v[46:47], v[42:43], v[36:37] op_sel:[0,0] op_sel_hi:[1,0]
    v_cvt_pk_bf16_f32 v16, v40, v41
    v_cvt_pk_bf16_f32 v17, v42, v43
    v_pk_fma_f32 v[40:41], v[40:41], v[38:39], v[44:45] op_sel:[1,0,0] op_sel_hi:[0,0,1] neg_lo:[1,0,0]
    v_pk_fma_f32 v[42:43], v[42:43], v[38:39], v[46:47] op_sel:[1,0,0] op_sel_hi:[0,0,1] neg_lo:[1,0,0]
    ds_write_addtid_b32 v16 offset:1088
    ds_write_addtid_b32 v17 offset:1360
    s_mov_b32 m0, s78
    v_pk_mul_f32 v[44:45], v[40:41], v[36:37] op_sel:[0,0] op_sel_hi:[1,0]
    v_pk_mul_f32 v[46:47], v[42:43], v[36:37] op_sel:[0,0] op_sel_hi:[1,0]
    v_cvt_pk_bf16_f32 v18, v40, v41
    v_cvt_pk_bf16_f32 v19, v42, v43
    v_pk_fma_f32 v[40:41], v[40:41], v[38:39], v[44:45] op_sel:[1,0,0] op_sel_hi:[0,0,1] neg_lo:[1,0,0]
    v_pk_fma_f32 v[42:43], v[42:43], v[38:39], v[46:47] op_sel:[1,0,0] op_sel_hi:[0,0,1] neg_lo:[1,0,0]
    ds_write_addtid_b32 v18 offset:1632
    ds_write_addtid_b32 v19 offset:1904
    s_mov_b32 m0, s78
    v_pk_mul_f32 v[44:45], v[40:41], v[36:37] op_sel:[0,0] op_sel_hi:[1,0]
    v_pk_mul_f32 v[46:47], v[42:43], v[36:37] op_sel:[0,0] op_sel_hi:[1,0]
    v_cvt_pk_bf16_f32 v16, v40, v41
    v_cvt_pk_bf16_f32 v17, v42, v43
    v_pk_fma_f32 v[40:41], v[40:41], v[38:39], v[44:45] op_sel:[1,0,0] op_sel_hi:[0,0,1] neg_lo:[1,0,0]
    v_pk_fma_f32 v[42:43], v[42:43], v[38:39], v[46:47] op_sel:[1,0,0] op_sel_hi:[0,0,1] neg_lo:[1,0,0]
    ds_write_addtid_b32 v16 offset:2176
    ds_write_addtid_b32 v17 offset:2448
    s_mov_b32 m0, s78
    v_pk_mul_f32 v[44:45], v[40:41], v[36:37] op_sel:[0,0] op_sel_hi:[1,0]
    v_pk_mul_f32 v[46:47], v[42:43], v[36:37] op_sel:[0,0] op_sel_hi:[1,0]
    v_cvt_pk_bf16_f32 v18, v40, v41
    v_cvt_pk_bf16_f32 v19, v42, v43
    v_pk_fma_f32 v[40:41], v[40:41], v[38:39], v[44:45] op_sel:[1,0,0] op_sel_hi:[0,0,1] neg_lo:[1,0,0]
    v_pk_fma_f32 v[42:43], v[42:43], v[38:39], v[46:47] op_sel:[1,0,0] op_sel_hi:[0,0,1] neg_lo:[1,0,0]
    ds_write_addtid_b32 v18 offset:2720
    ds_write_addtid_b32 v19 offset:2992
    s_mov_b32 m0, s78
    v_pk_mul_f32 v[44:45], v[40:41], v[36:37] op_sel:[0,0] op_sel_hi:[1,0]
    v_pk_mul_f32 v[46:47], v[42:43], v[36:37] op_sel:[0,0] op_sel_hi:[1,0]
    v_cvt_pk_bf16_f32 v16, v40, v41
    v_cvt_pk_bf16_f32 v17, v42, v43
    v_pk_fma_f32 v[40:41], v[40:41], v[38:39], v[44:45] op_sel:[1,0,0] op_sel_hi:[0,0,1] neg_lo:[1,0,0]
    v_pk_fma_f32 v[42:43], v[42:43], v[38:39], v[46:47] op_sel:[1,0,0] op_sel_hi:[0,0,1] neg_lo:[1,0,0]
    ds_write_addtid_b32 v16 offset:3264
    ds_write_addtid_b32 v17 offset:3536
    s_mov_b32 m0, s78
    v_pk_mul_f32 v[44:45], v[40:41], v[36:37] op_sel:[0,0] op_sel_hi:[1,0]
    v_pk_mul_f32 v[46:47], v[42:43], v[36:37] op_sel:[0,0] op_sel_hi:[1,0]
    v_cvt_pk_bf16_f32 v18, v40, v41
    v_cvt_pk_bf16_f32 v19, v42, v43
    v_pk_fma_f32 v[40:41], v[40:41], v[38:39], v[44:45] op_sel:[1,0,0] op_sel_hi:[0,0,1] neg_lo:[1,0,0]
    v_pk_fma_f32 v[42:43], v[42:43], v[38:39], v[46:47] op_sel:[1,0,0] op_sel_hi:[0,0,1] neg_lo:[1,0,0]
    ds_write_addtid_b32 v18 offset:3808
    ds_write_addtid_b32 v19 offset:4080
    s_barrier
    s_cmp_lg_u32 s3, 4
    s_cbranch_scc1 Lnn_22
    v_mov_b32 v1, 0
    global_load_dword v2, v1, s[30:31] sc1
Lnn_22:
    s_mov_b32 m0, s78
    v_mul_f32 v44, v41, v37
    v_mul_f32 v45, v41, v36
    v_mul_f32 v46, v43, v37
    v_mul_f32 v47, v43, v36
    v_cvt_pk_bf16_f32 v16, v40, v41
    v_cvt_pk_bf16_f32 v17, v42, v43
    v_fma_f32 v41, v40, v37, v45
    v_fma_f32 v40, v40, v36, -v44
    v_fma_f32 v43, v42, v37, v47
    v_fma_f32 v42, v42, v36, -v46
    ds_write_addtid_b32 v16 offset:4352
    ds_write_addtid_b32 v17 offset:4624
    s_mov_b32 m0, s78
    v_mul_f32 v44, v41, v37
    v_mul_f32 v45, v41, v36
    v_mul_f32 v46, v43, v37
    v_mul_f32 v47, v43, v36
    v_cvt_pk_bf16_f32 v18, v40, v41
    v_cvt_pk_bf16_f32 v19, v42, v43
    v_fma_f32 v41, v40, v37, v45
    v_fma_f32 v40, v40, v36, -v44
    v_fma_f32 v43, v42, v37, v47
    v_fma_f32 v42, v42, v36, -v46
    ds_write_addtid_b32 v18 offset:4896
    ds_write_addtid_b32 v19 offset:5168
    s_mov_b32 m0, s78
    v_mul_f32 v44, v41, v37
    v_mul_f32 v45, v41, v36
    v_mul_f32 v46, v43, v37
    v_mul_f32 v47, v43, v36
    v_cvt_pk_bf16_f32 v16, v40, v41
    v_cvt_pk_bf16_f32 v17, v42, v43
    v_fma_f32 v41, v40, v37, v45
    v_fma_f32 v40, v40, v36, -v44
    v_fma_f32 v43, v42, v37, v47
    v_fma_f32 v42, v42, v36, -v46
    ds_write_addtid_b32 v16 offset:5440
    ds_write_addtid_b32 v17 offset:5712
    s_mov_b32 m0, s78
    v_mul_f32 v44, v41, v37
    v_mul_f32 v45, v41, v36
    v_mul_f32 v46, v43, v37
    v_mul_f32 v47, v43, v36
    v_cvt_pk_bf16_f32 v18, v40, v41
    v_cvt_pk_bf16_f32 v19, v42, v43
    v_fma_f32 v41, v40, v37, v45
    v_fma_f32 v40, v40, v36, -v44
    v_fma_f32 v43, v42, v37, v47
    v_fma_f32 v42, v42, v36, -v46
    ds_write_addtid_b32 v18 offset:5984
    ds_write_addtid_b32 v19 offset:6256
    s_mov_b32 m0, s78
    v_mul_f32 v44, v41, v37
    v_mul_f32 v45, v41, v36
    v_mul_f32 v46, v43, v37
    v_mul_f32 v47, v43, v36
    v_cvt_pk_bf16_f32 v16, v40, v41
    v_cvt_pk_bf16_f32 v17, v42, v43
    v_fma_f32 v41, v40, v37, v45
    v_fma_f32 v40, v40, v36, -v44
    v_fma_f32 v43, v42, v37, v47
    v_fma_f32 v42, v42, v36, -v46
    ds_write_addtid_b32 v16 offset:6528
    ds_write_addtid_b32 v17 offset:6800
    s_mov_b32 m0, s78
    v_mul_f32 v44, v41, v37
    v_mul_f32 v45, v41, v36
    v_mul_f32 v46, v43, v37
    v_mul_f32 v47, v43, v36
    v_cvt_pk_bf16_f32 v18, v40, v41
    v_cvt_pk_bf16_f32 v19, v42, v43
    v_fma_f32 v41, v40, v37, v45
    v_fma_f32 v40, v40, v36, -v44
    v_fma_f32 v43, v42, v37, v47
    v_fma_f32 v42, v42, v36, -v46
    ds_write_addtid_b32 v18 offset:7072
    ds_write_addtid_b32 v19 offset:7344
    s_mov_b32 m0, s78
    v_mul_f32 v44, v41, v37
    v_mul_f32 v45, v41, v36
    v_mul_f32 v46, v43, v37
    v_mul_f32 v47, v43, v36
    v_cvt_pk_bf16_f32 v16, v40, v41
    v_cvt_pk_bf16_f32 v17, v42, v43
    v_fma_f32 v41, v40, v37, v45
    v_fma_f32 v40, v40, v36, -v44
    v_fma_f32 v43, v42, v37, v47
    v_fma_f32 v42, v42, v36, -v46
    ds_write_addtid_b32 v16 offset:7616
    ds_write_addtid_b32 v17 offset:7888
    s_mov_b32 m0, s78
    v_mul_f32 v44, v41, v37
    v_mul_f32 v45, v41, v36
    v_mul_f32 v46, v43, v37
    v_mul_f32 v47, v43, v36
    v_cvt_pk_bf16_f32 v18, v40, v41
    v_cvt_pk_bf16_f32 v19, v42, v43
    v_fma_f32 v41, v40, v37, v45
    v_fma_f32 v40, v40, v36, -v44
    v_fma_f32 v43, v42, v37, v47
    v_fma_f32 v42, v42, v36, -v46
    ds_write_addtid_b32 v18 offset:8160
    ds_write_addtid_b32 v19 offset:8432
    s_mov_b32 m0, s78
    s_waitcnt lgkmcnt(0)
    ds_read_b128 v[80:83], v21 offset:0
    ds_read_b128 v[84:87], v21 offset:32
    ds_read_b128 v[88:91], v21 offset:64
    ds_read_b128 v[92:95], v21 offset:96
    ds_read_b128 v[96:99], v21 offset:128
    ds_read_b128 v[100:103], v21 offset:160
    ds_read_b128 v[104:107], v21 offset:192
    ds_read_b128 v[108:111], v21 offset:224
    s_waitcnt lgkmcnt(7)
    v_mfma_f32_32x32x16_bf16 v[112:127], v[48:51], v[80:83], 0
    s_waitcnt lgkmcnt(6)
    v_mfma_f32_32x32x16_bf16 v[112:127], v[52:55], v[84:87], v[112:127]
    s_waitcnt lgkmcnt(5)
    v_mfma_f32_32x32x16_bf16 v[112:127], v[56:59], v[88:91], v[112:127]
    s_waitcnt lgkmcnt(4)
    v_mfma_f32_32x32x16_bf16 v[112:127], v[60:63], v[92:95], v[112:127]
    s_waitcnt lgkmcnt(3)
    v_mfma_f32_32x32x16_bf16 v[112:127], v[64:67], v[96:99], v[112:127]
    s_waitcnt lgkmcnt(2)
    v_mfma_f32_32x32x16_bf16 v[112:127], v[68:71], v[100:103], v[112:127]
    s_waitcnt lgkmcnt(1)
    v_mfma_f32_32x32x16_bf16 v[112:127], v[72:75], v[104:107], v[112:127]
    s_waitcnt lgkmcnt(0)
    v_mfma_f32_32x32x16_bf16 v[112:127], v[76:79], v[108:111], v[112:127]
    s_mov_b32 m0, s78
    v_mul_f32 v44, v41, v37
    v_mul_f32 v45, v41, v36
    v_mul_f32 v46, v43, v37
    v_mul_f32 v47, v43, v36
    v_cvt_pk_bf16_f32 v16, v40, v41
    v_cvt_pk_bf16_f32 v17, v42, v43
    v_fma_f32 v41, v40, v37, v45
    v_fma_f32 v40, v40, v36, -v44
    v_fma_f32 v43, v42, v37, v47
    v_fma_f32 v42, v42, v36, -v46
    ds_write_addtid_b32 v16 offset:0
    ds_write_addtid_b32 v17 offset:272
    s_mov_b32 m0, s78
    v_mul_f32 v44, v41, v37
    v_mul_f32 v45, v41, v36
    v_mul_f32 v46, v43, v37
    v_mul_f32 v47, v43, v36
    v_cvt_pk_bf16_f32 v18, v40, v41
    v_cvt_pk_bf16_f32 v19, v42, v43
    v_fma_f32 v41, v40, v37, v45
    v_fma_f32 v40, v40, v36, -v44
    v_fma_f32 v43, v42, v37, v47
    v_fma_f32 v42, v42, v36, -v46
    ds_write_addtid_b32 v18 offset:544
    ds_write_addtid_b32 v19 offset:816
    s_mov_b32 m0, s78
    v_mul_f32 v44, v41, v37
    v_mul_f32 v45, v41, v36
    v_mul_f32 v46, v43, v37
    v_mul_f32 v47, v43, v36
    v_cvt_pk_bf16_f32 v16, v40, v41
    v_cvt_pk_bf16_f32 v17, v42, v43
    v_fma_f32 v41, v40, v37, v45
    v_fma_f32 v40, v40, v36, -v44
    v_fma_f32 v43, v42, v37, v47
    v_fma_f32 v42, v42, v36, -v46
    ds_write_addtid_b32 v16 offset:1088
    ds_write_addtid_b32 v17 offset:1360
    s_mov_b32 m0, s78
    v_mul_f32 v44, v41, v37
    v_mul_f32 v45, v41, v36
    v_mul_f32 v46, v43, v37
    v_mul_f32 v47, v43, v36
    v_cvt_pk_bf16_f32 v18, v40, v41
    v_cvt_pk_bf16_f32 v19, v42, v43
    v_fma_f32 v41, v40, v37, v45
    v_fma_f32 v40, v40, v36, -v44
    v_fma_f32 v43, v42, v37, v47
    v_fma_f32 v42, v42, v36, -v46
    ds_write_addtid_b32 v18 offset:1632
    ds_write_addtid_b32 v19 offset:1904
    s_mov_b32 m0, s78
    v_mul_f32 v44, v41, v37
    v_mul_f32 v45, v41, v36
    v_mul_f32 v46, v43, v37
    v_mul_f32 v47, v43, v36
    v_cvt_pk_bf16_f32 v16, v40, v41
    v_cvt_pk_bf16_f32 v17, v42, v43
    v_fma_f32 v41, v40, v37, v45
    v_fma_f32 v40, v40, v36, -v44
    v_fma_f32 v43, v42, v37, v47
    v_fma_f32 v42, v42, v36, -v46
    ds_write_addtid_b32 v16 offset:2176
    ds_write_addtid_b32 v17 offset:2448
    s_mov_b32 m0, s78
    v_mul_f32 v44, v41, v37
    v_mul_f32 v45, v41, v36
    v_mul_f32 v46, v43, v37
    v_mul_f32 v47, v43, v36
    v_cvt_pk_bf16_f32 v18, v40, v41
    v_cvt_pk_bf16_f32 v19, v42, v43
    v_fma_f32 v41, v40, v37, v45
    v_fma_f32 v40, v40, v36, -v44
    v_fma_f32 v43, v42, v37, v47
    v_fma_f32 v42, v42, v36, -v46
    ds_write_addtid_b32 v18 offset:2720
    ds_write_addtid_b32 v19 offset:2992
    s_mov_b32 m0, s78
    v_mul_f32 v44, v41, v37
    v_mul_f32 v45, v41, v36
    v_mul_f32 v46, v43, v37
    v_mul_f32 v47, v43, v36
    v_cvt_pk_bf16_f32 v16, v40, v41
    v_cvt_pk_bf16_f32 v17, v42, v43
    v_fma_f32 v41, v40, v37, v45
    v_fma_f32 v40, v40, v36, -v44
    v_fma_f32 v43, v42, v37, v47
    v_fma_f32 v42, v42, v36, -v46
    ds_write_addtid_b32 v16 offset:3264
    ds_write_addtid_b32 v17 offset:3536
    s_mov_b32 m0, s78
    v_mul_f32 v44, v41, v37
    v_mul_f32 v45, v41, v36
    v_mul_f32 v46, v43, v37
    v_mul_f32 v47, v43, v36
    v_cvt_pk_bf16_f32 v18, v40, v41
    v_cvt_pk_bf16_f32 v19, v42, v43
    v_fma_f32 v41, v40, v37, v45
    v_fma_f32 v40, v40, v36, -v44
    v_fma_f32 v43, v42, v37, v47
    v_fma_f32 v42, v42, v36, -v46
    ds_write_addtid_b32 v18 offset:3808
    ds_write_addtid_b32 v19 offset:4080
    s_mov_b32 m0, s78
    v_mul_f32 v44, v41, v37
    v_mul_f32 v45, v41, v36
    v_mul_f32 v46, v43, v37
    v_mul_f32 v47, v43, v36
    v_cvt_pk_bf16_f32 v16, v40, v41
    v_cvt_pk_bf16_f32 v17, v42, v43
    v_fma_f32 v41, v40, v37, v45
    v_fma_f32 v40, v40, v36, -v44
    v_fma_f32 v43, v42, v37, v47
    v_fma_f32 v42, v42, v36, -v46
    ds_write_addtid_b32 v16 offset:4352
    ds_write_addtid_b32 v17 offset:4624
    s_mov_b32 m0, s78
    v_mul_f32 v44, v41, v37
    v_mul_f32 v45, v41, v36
    v_mul_f32 v46, v43, v37
    v_mul_f32 v47, v43, v36
    v_cvt_pk_bf16_f32 v18, v40, v41
    v_cvt_pk_bf16_f32 v19, v42, v43
    v_fma_f32 v41, v40, v37, v45
    v_fma_f32 v40, v40, v36, -v44
    v_fma_f32 v43, v42, v37, v47
    v_fma_f32 v42, v42, v36, -v46
    ds_write_addtid_b32 v18 offset:4896
    ds_write_addtid_b32 v19 offset:5168
    s_mov_b32 m0, s78
    v_mul_f32 v44, v41, v37
    v_mul_f32 v45, v41, v36
    v_mul_f32 v46, v43, v37
    v_mul_f32 v47, v43, v36
    v_cvt_pk_bf16_f32 v16, v40, v41
    v_cvt_pk_bf16_f32 v17, v42, v43
    v_fma_f32 v41, v40, v37, v45
    v_fma_f32 v40, v40, v36, -v44
    v_fma_f32 v43, v42, v37, v47
    v_fma_f32 v42, v42, v36, -v46
    ds_write_addtid_b32 v16 offset:5440
    ds_write_addtid_b32 v17 offset:5712
    s_mov_b32 m0, s78
    v_mul_f32 v44, v41, v37
    v_mul_f32 v45, v41, v36
    v_mul_f32 v46, v43, v37
    v_mul_f32 v47, v43, v36
    v_cvt_pk_bf16_f32 v18, v40, v41
    v_cvt_pk_bf16_f32 v19, v42, v43
    v_fma_f32 v41, v40, v37, v45
    v_fma_f32 v40, v40, v36, -v44
    v_fma_f32 v43, v42, v37, v47
    v_fma_f32 v42, v42, v36, -v46
    ds_write_addtid_b32 v18 offset:5984
    ds_write_addtid_b32 v19 offset:6256
    s_mov_b32 m0, s78
    v_mul_f32 v44, v41, v37
    v_mul_f32 v45, v41, v36
    v_mul_f32 v46, v43, v37
    v_mul_f32 v47, v43, v36
    v_cvt_pk_bf16_f32 v16, v40, v41
    v_cvt_pk_bf16_f32 v17, v42, v43
    v_fma_f32 v41, v40, v37, v45
    v_fma_f32 v40, v40, v36, -v44
    v_fma_f32 v43, v42, v37, v47
    v_fma_f32 v42, v42, v36, -v46
    ds_write_addtid_b32 v16 offset:6528
    ds_write_addtid_b32 v17 offset:6800
    s_mov_b32 m0, s78
    v_mul_f32 v44, v41, v37
    v_mul_f32 v45, v41, v36
    v_mul_f32 v46, v43, v37
    v_mul_f32 v47, v43, v36
    v_cvt_pk_bf16_f32 v18, v40, v41
    v_cvt_pk_bf16_f32 v19, v42, v43
    v_fma_f32 v41, v40, v37, v45
    v_fma_f32 v40, v40, v36, -v44
    v_fma_f32 v43, v42, v37, v47
    v_fma_f32 v42, v42, v36, -v46
    ds_write_addtid_b32 v18 offset:7072
    ds_write_addtid_b32 v19 offset:7344
    s_mov_b32 m0, s78
    v_mul_f32 v44, v41, v37
    v_mul_f32 v45, v41, v36
    v_mul_f32 v46, v43, v37
    v_mul_f32 v47, v43, v36
    v_cvt_pk_bf16_f32 v16, v40, v41
    v_cvt_pk_bf16_f32 v17, v42, v43
    v_fma_f32 v41, v40, v37, v45
    v_fma_f32 v40, v40, v36, -v44
    v_fma_f32 v43, v42, v37, v47
    v_fma_f32 v42, v42, v36, -v46
    ds_write_addtid_b32 v16 offset:7616
    ds_write_addtid_b32 v17 offset:7888
    s_mov_b32 m0, s78
    v_mul_f32 v44, v41, v37
    v_mul_f32 v45, v41, v36
    v_cvt_pk_bf16_f32 v18, v40, v41
    v_cvt_pk_bf16_f32 v19, v42, v43
    v_fma_f32 v41, v40, v37, v45
    v_fma_f32 v40, v40, v36, -v44
    ds_write_addtid_b32 v18 offset:8160
    ds_write_addtid_b32 v19 offset:8432
    s_mov_b32 m0, s78
    s_waitcnt lgkmcnt(0)
    ds_read_b128 v[80:83], v21 offset:0
    ds_read_b128 v[84:87], v21 offset:32
    ds_read_b128 v[88:91], v21 offset:64
    ds_read_b128 v[92:95], v21 offset:96
    ds_read_b128 v[96:99], v21 offset:128
    ds_read_b128 v[100:103], v21 offset:160
    ds_read_b128 v[104:107], v21 offset:192
    ds_read_b128 v[108:111], v21 offset:224
    s_waitcnt lgkmcnt(7)
    v_mfma_f32_32x32x16_bf16 v[128:143], v[48:51], v[80:83], 0
    s_waitcnt lgkmcnt(6)
    v_mfma_f32_32x32x16_bf16 v[128:143], v[52:55], v[84:87], v[128:143]
    s_waitcnt lgkmcnt(5)
    v_mfma_f32_32x32x16_bf16 v[128:143], v[56:59], v[88:91], v[128:143]
    s_waitcnt lgkmcnt(4)
    v_mfma_f32_32x32x16_bf16 v[128:143], v[60:63], v[92:95], v[128:143]
    s_waitcnt lgkmcnt(3)
    v_mfma_f32_32x32x16_bf16 v[128:143], v[64:67], v[96:99], v[128:143]
    s_waitcnt lgkmcnt(2)
    v_mfma_f32_32x32x16_bf16 v[128:143], v[68:71], v[100:103], v[128:143]
    s_waitcnt lgkmcnt(1)
    v_mfma_f32_32x32x16_bf16 v[128:143], v[72:75], v[104:107], v[128:143]
    s_waitcnt lgkmcnt(0)
    v_mfma_f32_32x32x16_bf16 v[128:143], v[76:79], v[108:111], v[128:143]
    s_mov_b32 m0, s78
    v_add_f32_dpp v40, v40, v40 row_shr:1 row_mask:0xf bank_mask:0xf bound_ctrl:0
    s_nop 1
    v_add_f32_dpp v40, v40, v40 row_shr:2 row_mask:0xf bank_mask:0xf bound_ctrl:0
    s_nop 1
    v_add_f32_dpp v40, v40, v40 row_shr:4 row_mask:0xf bank_mask:0xf bound_ctrl:0
    s_nop 1
    v_add_f32_dpp v40, v40, v40 row_shr:8 row_mask:0xf bank_mask:0xf bound_ctrl:0
    s_nop 1
    v_add_f32_dpp v40, v40, v40 row_bcast:15 row_mask:0xa bank_mask:0xf
    s_nop 1
    v_add_f32_dpp v40, v40, v40 row_bcast:31 row_mask:0xc bank_mask:0xf
    v_lshl_add_u32 v13, v0, 4, s78
    s_cmp_eq_u32 s77, 1
    s_cbranch_scc1 Lkx_23
    ds_write_b128 v13, v[128:131] offset:0
    ds_write_b128 v13, v[132:135] offset:1024
    ds_write_b128 v13, v[136:139] offset:2048
    ds_write_b128 v13, v[140:143] offset:3072
    s_branch Lkx_24
Lkx_23:
    ds_write_b128 v13, v[112:115] offset:0
    ds_write_b128 v13, v[116:119] offset:1024
    ds_write_b128 v13, v[120:123] offset:2048
    ds_write_b128 v13, v[124:127] offset:3072
    v_mov_b32 v112, v128
    v_mov_b32 v113, v129
    v_mov_b32 v114, v130
    v_mov_b32 v115, v131
    v_mov_b32 v116, v132
    v_mov_b32 v117, v133
    v_mov_b32 v118, v134
    v_mov_b32 v119, v135
    v_mov_b32 v120, v136
    v_mov_b32 v121, v137
    v_mov_b32 v122, v138
    v_mov_b32 v123, v139
    v_mov_b32 v124, v140
    v_mov_b32 v125, v141
    v_mov_b32 v126, v142
    v_mov_b32 v127, v143
Lkx_24:
    v_mov_b32 v14, s78
    v_cmp_eq_u32 vcc, 63, v0
    s_nop 2
    s_and_saveexec_b64 s[74:75], vcc
    ds_write_b32 v14, v40 offset:4096
    s_mov_b64 exec, s[74:75]
    s_waitcnt lgkmcnt(0)
    v_lshlrev_b32 v146, 16, v146
    v_lshlrev_b32 v144, 2, v145
    v_add_u32 v144, 151296, v144
    v_cmp_gt_u32 vcc, 192, v145
    s_nop 2
    s_and_saveexec_b64 s[74:75], vcc
    ds_write_b32 v144, v146
    s_mov_b64 exec, s[74:75]
    v_lshlrev_b32 v147, 16, v147
    s_nop 0
    v_readfirstlane_b32 s35, v147
    s_cmp_lg_u32 s3, 4
    s_cbranch_scc1 Lnn_25
    s_mov_b32 s82, 200000
Lnp_26:
    s_waitcnt vmcnt(0)
    v_readfirstlane_b32 s62, v2
    s_nop 2
    s_cmp_lg_u32 s62, 0
    s_cbranch_scc1 Lnq_27
    s_sub_u32 s82, s82, 1
    s_cmp_eq_u32 s82, 0
    s_cbranch_scc1 Lnq_27
    s_sleep 2
    v_mov_b32 v1, 0
    global_load_dword v2, v1, s[30:31] sc1
    s_branch Lnp_26
Lnq_27:
    v_mov_b32 v1, 152096
    ds_write_b32 v1, v2
Lnn_25:
    s_waitcnt lgkmcnt(0)
    s_setprio 0
    s_barrier
    s_add_u32 s79, s56, 2
    s_and_b32 s79, s79, 7
    s_lshl_b32 s79, s79, 6
    s_lshr_b32 s63, s61, 1
    s_lshl_b32 s63, s63, 5
    s_add_u32 s79, s79, s63
    s_and_b32 s63, s61, 1
    s_lshl_b32 s63, s63, 2
    s_add_u32 s79, s79, s63
    s_mul_i32 s79, s79, 2752
    s_lshl_b32 s63, s54, 6
    s_add_u32 s79, s79, s63
    s_mul_i32 s81, s61, 6144
    s_add_u32 m0, s81, 34816
    s_nop 0
    buffer_load_dwordx4 v232, s[40:43], s79 offen lds
    s_add_u32 m0, s81, 35840
    s_nop 0
    buffer_load_dwordx4 v233, s[40:43], s79 offen lds
    s_add_u32 m0, s81, 36864
    s_nop 0
    buffer_load_dwordx4 v234, s[40:43], s79 offen lds
    s_add_u32 s79, s79, 44032
    s_add_u32 m0, s81, 37888
    s_nop 0
    buffer_load_dwordx4 v232, s[40:43], s79 offen lds
    s_add_u32 m0, s81, 38912
    s_nop 0
    buffer_load_dwordx4 v233, s[40:43], s79 offen lds
    s_add_u32 m0, s81, 39936
    s_nop 0
    buffer_load_dwordx4 v234, s[40:43], s79 offen lds
    v_mov_b32 v1, 152096
    ds_read_b32 v1, v1
    s_waitcnt lgkmcnt(0)
    v_readfirstlane_b32 s34, v1
    s_barrier
    s_add_u32 s79, s56, 3
    s_and_b32 s79, s79, 7
    s_lshl_b32 s79, s79, 6
    s_lshr_b32 s63, s61, 1
    s_lshl_b32 s63, s63, 5
    s_add_u32 s79, s79, s63
    s_and_b32 s63, s61, 1
    s_lshl_b32 s63, s63, 2
    s_add_u32 s79, s79, s63
    s_mul_i32 s79, s79, 2752
    s_lshl_b32 s63, s54, 6
    s_add_u32 s79, s79, s63
    s_mul_i32 s81, s61, 6144
    s_add_u32 m0, s81, 59392
    s_nop 0
    buffer_load_dwordx4 v232, s[40:43], s79 offen lds
    s_add_u32 m0, s81, 60416
    s_nop 0
    buffer_load_dwordx4 v233, s[40:43], s79 offen lds
    s_add_u32 m0, s81, 61440
    s_nop 0
    buffer_load_dwordx4 v234, s[40:43], s79 offen lds
    s_add_u32 s79, s79, 44032
    s_add_u32 m0, s81, 62464
    s_nop 0
    buffer_load_dwordx4 v232, s[40:43], s79 offen lds
    s_add_u32 m0, s81, 63488
    s_nop 0
    buffer_load_dwordx4 v233, s[40:43], s79 offen lds
    s_add_u32 m0, s81, 64512
    s_nop 0
    buffer_load_dwordx4 v234, s[40:43], s79 offen lds
    s_waitcnt vmcnt(6)
    s_barrier
    s_add_u32 s79, s56, 4
    s_and_b32 s79, s79, 7
    s_lshl_b32 s79, s79, 6
    s_lshr_b32 s63, s61, 1
    s_lshl_b32 s63, s63, 5
    s_add_u32 s79, s79, s63
    s_and_b32 s63, s61, 1
    s_lshl_b32 s63, s63, 2
    s_add_u32 s79, s79, s63
    s_mul_i32 s79, s79, 2752
    s_lshl_b32 s63, s54, 6
    s_add_u32 s79, s79, s63
    s_mul_i32 s81, s61, 6144
    s_add_u32 m0, s81, 100352
    s_nop 0
    buffer_load_dwordx4 v232, s[40:43], s79 offen lds
    s_add_u32 m0, s81, 101376
    s_nop 0
    buffer_load_dwordx4 v233, s[40:43], s79 offen lds
    s_add_u32 m0, s81, 102400
    s_nop 0
    buffer_load_dwordx4 v234, s[40:43], s79 offen lds
    s_add_u32 s79, s79, 44032
    s_add_u32 m0, s81, 103424
    s_nop 0
    buffer_load_dwordx4 v232, s[40:43], s79 offen lds
    s_add_u32 m0, s81, 104448
    s_nop 0
    buffer_load_dwordx4 v233, s[40:43], s79 offen lds
    s_add_u32 m0, s81, 105472
    s_nop 0
    buffer_load_dwordx4 v234, s[40:43], s79 offen lds
    s_waitcnt vmcnt(6)
    s_barrier
    s_add_u32 s79, s56, 5
    s_and_b32 s79, s79, 7
    s_lshl_b32 s79, s79, 6
    s_lshr_b32 s63, s61, 1
    s_lshl_b32 s63, s63, 5
    s_add_u32 s79, s79, s63
    s_and_b32 s63, s61, 1
    s_lshl_b32 s63, s63, 2
    s_add_u32 s79, s79, s63
    s_mul_i32 s79, s79, 2752
    s_lshl_b32 s63, s54, 6
    s_add_u32 s79, s79, s63
    s_mul_i32 s81, s61, 6144
    s_add_u32 m0, s81, 124928
    s_nop 0
    buffer_load_dwordx4 v232, s[40:43], s79 offen lds
    s_add_u32 m0, s81, 125952
    s_nop 0
    buffer_load_dwordx4 v233, s[40:43], s79 offen lds
    s_add_u32 m0, s81, 126976
    s_nop 0
    buffer_load_dwordx4 v234, s[40:43], s79 offen lds
    s_add_u32 s79, s79, 44032
    s_add_u32 m0, s81, 128000
    s_nop 0
    buffer_load_dwordx4 v232, s[40:43], s79 offen lds
    s_add_u32 m0, s81, 129024
    s_nop 0
    buffer_load_dwordx4 v233, s[40:43], s79 offen lds
    s_add_u32 m0, s81, 130048
    s_nop 0
    buffer_load_dwordx4 v234, s[40:43], s79 offen lds
    s_waitcnt vmcnt(6)
    s_barrier
    s_cmp_lg_u32 s3, 4
    s_cbranch_scc1 Lsa_28
    s_lshl_b32 s62, s53, 5
    s_add_u32 s62, s62, s52
    s_lshl_b32 s62, s62, 6
    s_add_u32 s62, s62, 4096
    v_mov_b32 v1, 0
    v_mov_b32 v2, s34
    s_mov_b64 s[74:75], exec
    s_mov_b64 exec, 1
    buffer_store_dword v2, v1, s[44:47], s62 offen sc1
    s_mov_b64 exec, s[74:75]
Lsa_28:
    s_add_u32 s79, s56, 6
    s_and_b32 s79, s79, 7
    s_lshl_b32 s79, s79, 6
    s_lshr_b32 s63, s61, 1
    s_lshl_b32 s63, s63, 5
    s_add_u32 s79, s79, s63
    s_and_b32 s63, s61, 1
    s_lshl_b32 s63, s63, 2
    s_add_u32 s79, s79, s63
    s_mul_i32 s79, s79, 2752
    s_lshl_b32 s63, s54, 6
    s_add_u32 s79, s79, s63
    s_mul_i32 s81, s61, 6144
    s_add_u32 m0, s81, 34816
    s_nop 0
    buffer_load_dwordx4 v232, s[40:43], s79 offen lds
    s_add_u32 m0, s81, 35840
    s_nop 0
    buffer_load_dwordx4 v233, s[40:43], s79 offen lds
    s_add_u32 m0, s81, 36864
    s_nop 0
    buffer_load_dwordx4 v234, s[40:43], s79 offen lds
    s_add_u32 s79, s79, 44032
    s_add_u32 m0, s81, 37888
    s_nop 0
    buffer_load_dwordx4 v232, s[40:43], s79 offen lds
    s_add_u32 m0, s81, 38912
    s_nop 0
    buffer_load_dwordx4 v233, s[40:43], s79 offen lds
    s_add_u32 m0, s81, 39936
    s_nop 0
    buffer_load_dwordx4 v234, s[40:43], s79 offen lds
    s_waitcnt vmcnt(6)
    s_barrier
    s_add_u32 s79, s56, 7
    s_and_b32 s79, s79, 7
    s_lshl_b32 s79, s79, 6
    s_lshr_b32 s63, s61, 1
    s_lshl_b32 s63, s63, 5
    s_add_u32 s79, s79, s63
    s_and_b32 s63, s61, 1
    s_lshl_b32 s63, s63, 2
    s_add_u32 s79, s79, s63
    s_mul_i32 s79, s79, 2752
    s_lshl_b32 s63, s54, 6
    s_add_u32 s79, s79, s63
    s_mul_i32 s81, s61, 6144
    s_add_u32 m0, s81, 59392
    s_nop 0
    buffer_load_dwordx4 v232, s[40:43], s79 offen lds
    s_add_u32 m0, s81, 60416
    s_nop 0
    buffer_load_dwordx4 v233, s[40:43], s79 offen lds
    s_add_u32 m0, s81, 61440
    s_nop 0
    buffer_load_dwordx4 v234, s[40:43], s79 offen lds
    s_add_u32 s79, s79, 44032
    s_add_u32 m0, s81, 62464
    s_nop 0
    buffer_load_dwordx4 v232, s[40:43], s79 offen lds
    s_add_u32 m0, s81, 63488
    s_nop 0
    buffer_load_dwordx4 v233, s[40:43], s79 offen lds
    s_add_u32 m0, s81, 64512
    s_nop 0
    buffer_load_dwordx4 v234, s[40:43], s79 offen lds
    s_mul_i32 s62, s61, 86
    v_add_u32 v154, s62, v0
    v_lshlrev_b32 v154, 7, v154
    s_lshr_b32 s62, s2, 3
    s_mul_i32 s62, s62, 44032
    s_mov_b32 s64, s24
    s_and_b32 s65, s25, 0xffff
    s_mov_b32 s66, 1409024
    s_mov_b32 s67, 0x20000
    s_mov_b32 exec_lo, -1
    s_mov_b32 exec_hi, 0x7ff
    buffer_load_dword v164, v154, s[64:67], s62 offen
    s_add_u32 s62, s62, 5504
    buffer_load_dword v165, v154, s[64:67], s62 offen
    s_mov_b64 exec, -1
    s_waitcnt vmcnt(8)
    v_mov_b32 v1, 152216
    v_mov_b32 v2, 1
    s_mov_b64 s[74:75], exec
    s_mov_b64 exec, 1
    ds_add_u32 v1, v2
    s_mov_b64 exec, s[74:75]
    s_lshr_b32 s62, s61, 1
    s_mul_i32 s80, s62, 4608
    s_add_u32 s80, s80, 152592
    s_mul_i32 s83, s62, 17408
    s_add_u32 s83, s83, 0
    s_lshl_b32 s62, s77, 6
    v_add_u32 v152, s62, v0
    s_waitcnt vmcnt(2)
    v_mov_b32 v1, 152220
    v_mov_b32 v2, 1
    s_mov_b64 s[74:75], exec
    s_mov_b64 exec, 1
    ds_add_u32 v1, v2
    s_mov_b64 exec, s[74:75]
    v_lshlrev_b32 v150, 6, v0
    s_lshr_b32 s62, s2, 5
    s_lshl_b32 s62, s62, 11
    s_add_u32 s92, s62, 4096
    s_mov_b32 exec_lo, -1
    s_mov_b32 exec_hi, 0
    buffer_load_dword v151, v150, s[44:47], s92 offen sc1
    s_mov_b64 exec, -1
    s_mul_i32 s64, s77, 17408
    s_sub_u32 s64, 8704, s64
    s_add_u32 s64, s64, s78
    v_lshl_add_u32 v13, v0, 4, s64
    ds_read_b128 v[80:83], v13 offset:0
    ds_read_b128 v[84:87], v13 offset:1024
    ds_read_b128 v[88:91], v13 offset:2048
    ds_read_b128 v[92:95], v13 offset:3072
    v_mov_b32 v14, s64
    ds_read_b32 v15, v14 offset:4096
    v_and_b32 v16, 31, v0
    v_lshrrev_b32 v17, 5, v0
    v_lshlrev_b32 v16, 6, v16
    v_lshl_add_u32 v16, v17, 3, v16
    s_lshl_b32 s65, s77, 11
    s_sub_u32 s65, s80, s65
    s_add_u32 s65, s65, 4040
    v_sub_u32 v16, s65, v16
    s_waitcnt lgkmcnt(0)
    v_add_f32 v112, v112, v80
    v_add_f32 v113, v113, v81
    v_add_f32 v114, v114, v82
    v_add_f32 v115, v115, v83
    v_add_f32 v116, v116, v84
    v_add_f32 v117, v117, v85
    v_add_f32 v118, v118, v86
    v_add_f32 v119, v119, v87
    v_add_f32 v120, v120, v88
    v_add_f32 v121, v121, v89
    v_add_f32 v122, v122, v90
    v_add_f32 v123, v123, v91
    v_add_f32 v124, v124, v92
    v_add_f32 v125, v125, v93
    v_add_f32 v126, v126, v94
    v_add_f32 v127, v127, v95
    v_cvt_pk_bf16_f32 v80, v115, v114
    v_cvt_pk_bf16_f32 v81, v113, v112
    v_cvt_pk_bf16_f32 v82, v119, v118
    v_cvt_pk_bf16_f32 v83, v117, v116
    v_cvt_pk_bf16_f32 v84, v123, v122
    v_cvt_pk_bf16_f32 v85, v121, v120
    v_cvt_pk_bf16_f32 v86, v127, v126
    v_cvt_pk_bf16_f32 v87, v125, v124
    ds_write_b64 v16, v[80:81] offset:48
    ds_write_b64 v16, v[82:83] offset:32
    ds_write_b64 v16, v[84:85] offset:16
    ds_write_b64 v16, v[86:87] offset:0
    s_cmp_eq_u32 s77, 1
    s_cbranch_scc1 Lkf_29
    v_add_f32 v15, v15, v40
    v_cvt_pk_bf16_f32 v15, v15, v15
    v_mov_b32 v14, s80
    v_mov_b32 v18, 0
    v_mov_b32 v19, 0
    v_subrev_u32 v17, 2, v14
    v_cmp_eq_u32 vcc, 63, v0
    s_nop 2
    s_and_saveexec_b64 s[74:75], vcc
    ds_write_b16 v17, v15
    ds_write_b64 v14, v[18:19] offset:4096
    s_mov_b64 exec, s[74:75]
Lkf_29:
    s_waitcnt lgkmcnt(0)
    s_lshl_b32 s66, s61, 2
    s_add_u32 s66, s66, 152120
    v_mov_b32 v1, s66
    v_mov_b32 v2, 1
    ds_write_b32 v1, v2
    s_xor_b32 s66, s66, 4
    v_mov_b32 v1, s66
    s_mov_b32 s82, 1000000
Lps_30:
    ds_read_b32 v2, v1
    s_waitcnt lgkmcnt(0)
    v_readfirstlane_b32 s66, v2
    s_nop 2
    s_cmp_eq_u32 s66, 1
    s_cbranch_scc1 Lpd_31
    s_sub_u32 s82, s82, 1
    s_cmp_lg_u32 s82, 0
    s_cbranch_scc1 Lps_30
Lpd_31:
    s_waitcnt vmcnt(0)
    s_mov_b32 exec_lo, -1
    s_mov_b32 exec_hi, 0
    v_cmp_ne_u32 vcc, s34, v151
    s_mov_b64 exec, -1
    s_nop 4
    s_cbranch_vccz Lfa_32
    s_mov_b64 s[74:75], exec
    s_mov_b32 exec_lo, 0xffffffff
    s_mov_b32 exec_hi, 0
    s_mov_b32 s82, 200000
Lpoll_33:
    buffer_load_dword v151, v150, s[44:47], s92 offen sc1
    s_waitcnt vmcnt(0)
    v_cmp_ne_u32 vcc, s34, v151
    s_nop 4
    s_cbranch_vccz Lpolld_34
    s_sub_u32 s82, s82, 1
    s_cmp_eq_u32 s82, 0
    s_cbranch_scc1 Lpolld_34
    s_sleep 2
    s_branch Lpoll_33
Lpolld_34:
    s_mov_b64 exec, s[74:75]
Lfa_32:
    s_lshr_b32 s63, s61, 1
    s_lshl_b32 s64, s2, 1
    s_add_u32 s64, s64, s63
    s_lshl_b32 s64, s64, 12
    s_add_u32 s64, s64, 8388608
    v_lshlrev_b32 v153, 4, v152
    buffer_load_dwordx4 v[156:159], v153, s[44:47], s64 offen sc1
    buffer_load_dwordx4 v[160:163], v153, s[44:47], s64 offen offset:2048 sc1
    s_mul_i32 s65, s63, 4608
    s_add_u32 s65, s65, 152576
    v_add_u32 v153, s65, v153
    v_mov_b32 v8, v152
    v_lshl_add_u32 v13, v8, 4, s80
    v_subrev_u32 v13, 2, v13
    ds_read_u16 v16, v13
    ds_read_u16 v17, v13 offset:16
    v_lshl_add_u32 v14, v8, 4, s83
    v_and_b32 v12, 1, v8
    v_cmp_eq_u32 vcc, 0, v12
    s_waitcnt lgkmcnt(0)
    s_nop 0
    v_cndmask_b32 v18, v17, v16, vcc
    v_lshl_or_b32 v24, v16, 16, v16
    v_lshl_or_b32 v27, v17, 16, v17
    v_lshl_or_b32 v26, v17, 16, v18
    v_lshl_or_b32 v29, v18, 16, v16
    v_mov_b32 v25, v24
    v_mov_b32 v28, v24
    v_mov_b32 v30, v27
    v_mov_b32 v31, v27
    v_mov_b32 v32, v24
    v_mov_b32 v33, v26
    v_mov_b32 v34, v27
    v_mov_b32 v35, v27
    v_mov_b32 v36, v29
    v_mov_b32 v37, v27
    v_mov_b32 v38, v27
    v_mov_b32 v39, v27
    ds_write_b128 v14, v[24:27] offset:0
    ds_write_b128 v14, v[28:31] offset:4160
    ds_write_b128 v14, v[32:35] offset:8320
    ds_write_b128 v14, v[36:39] offset:12480
    v_add_u32 v13, 2048, v13
    v_add_u32 v14, 2048, v14
    s_cmp_eq_u32 s77, 1
    s_cbranch_scc1 Lcb_35
    ds_read_u16 v16, v13
    ds_read_u16 v17, v13 offset:8
    ds_read_u16 v18, v13 offset:16
    s_waitcnt lgkmcnt(0)
    v_lshl_or_b32 v24, v16, 16, v16
    v_lshl_or_b32 v25, v17, 16, v16
    v_lshl_or_b32 v26, v17, 16, v17
    v_lshl_or_b32 v27, v18, 16, v18
    v_lshl_or_b32 v30, v18, 16, v17
    v_mov_b32 v28, v24
    v_mov_b32 v29, v26
    v_mov_b32 v31, v27
    v_mov_b32 v32, v25
    v_mov_b32 v33, v26
    v_mov_b32 v34, v27
    v_mov_b32 v35, v27
    v_mov_b32 v36, v26
    v_mov_b32 v37, v30
    v_mov_b32 v38, v27
    v_mov_b32 v39, v27
    ds_write_b128 v14, v[24:27] offset:0
    ds_write_b128 v14, v[28:31] offset:4160
    ds_write_b128 v14, v[32:35] offset:8320
    ds_write_b128 v14, v[36:39] offset:12480
    s_branch Lcb_36
Lcb_35:
    ds_read_u16 v16, v13 offset:0
    ds_read_u16 v17, v13 offset:4
    ds_read_u16 v18, v13 offset:8
    ds_read_u16 v19, v13 offset:12
    ds_read_u16 v20, v13 offset:16
    ds_read_u16 v21, v13 offset:20
    v_subrev_u32 v12, 2, v13
    ds_read_b32 v56, v12
    ds_read_b32 v57, v12 offset:4
    ds_read_b32 v58, v12 offset:8
    ds_read_b32 v59, v12 offset:12
    ds_read_b32 v60, v12 offset:16
    ds_read_b32 v61, v12 offset:20
    s_waitcnt lgkmcnt(6)
    v_lshl_or_b32 v24, v16, 16, v16
    v_lshl_or_b32 v25, v18, 16, v17
    v_lshl_or_b32 v26, v18, 16, v18
    v_lshl_or_b32 v27, v20, 16, v19
    v_lshl_or_b32 v28, v17, 16, v16
    v_lshl_or_b32 v30, v19, 16, v18
    v_lshl_or_b32 v31, v20, 16, v20
    v_lshl_or_b32 v39, v21, 16, v20
    v_mov_b32 v29, v26
    v_mov_b32 v32, v25
    v_mov_b32 v33, v26
    v_mov_b32 v34, v27
    v_mov_b32 v35, v31
    v_mov_b32 v36, v26
    v_mov_b32 v37, v30
    v_mov_b32 v38, v31
    s_waitcnt lgkmcnt(0)
    v_alignbit_b32 v40, v57, v56, 16
    v_alignbit_b32 v41, v58, v57, 16
    v_alignbit_b32 v42, v59, v58, 16
    v_alignbit_b32 v43, v60, v59, 16
    v_mov_b32 v44, v57
    v_mov_b32 v45, v58
    v_mov_b32 v46, v59
    v_mov_b32 v47, v60
    v_mov_b32 v48, v41
    v_mov_b32 v49, v42
    v_mov_b32 v50, v43
    v_alignbit_b32 v51, v61, v60, 16
    v_mov_b32 v52, v58
    v_mov_b32 v53, v59
    v_mov_b32 v54, v60
    v_mov_b32 v55, v61
    v_cmp_lt_u32 vcc, 31, v0
    s_nop 1
    v_cndmask_b32 v24, v24, v40, vcc
    v_cndmask_b32 v25, v25, v41, vcc
    v_cndmask_b32 v26, v26, v42, vcc
    v_cndmask_b32 v27, v27, v43, vcc
    v_cndmask_b32 v28, v28, v44, vcc
    v_cndmask_b32 v29, v29, v45, vcc
    v_cndmask_b32 v30, v30, v46, vcc
    v_cndmask_b32 v31, v31, v47, vcc
    v_cndmask_b32 v32, v32, v48, vcc
    v_cndmask_b32 v33, v33, v49, vcc
    v_cndmask_b32 v34, v34, v50, vcc
    v_cndmask_b32 v35, v35, v51, vcc
    v_cndmask_b32 v36, v36, v52, vcc
    v_cndmask_b32 v37, v37, v53, vcc
    v_cndmask_b32 v38, v38, v54, vcc
    v_cndmask_b32 v39, v39, v55, vcc
    ds_write_b128 v14, v[24:27] offset:0
    ds_write_b128 v14, v[28:31] offset:4160
    ds_write_b128 v14, v[32:35] offset:8320
    ds_write_b128 v14, v[36:39] offset:12480
Lcb_36:
    s_waitcnt lgkmcnt(0)
    v_mov_b32 v18, s80
    ds_read_u16 v19, v18 offset:4094
    ds_read_u16 v20, v18 offset:3074
    ds_read_u16 v21, v18 offset:3584
    s_mov_b64 s[74:75], exec
    s_cmp_eq_u32 s77, 1
    s_cbranch_scc1 Ltp_37
    v_and_b32 v12, 3, v0
    v_lshrrev_b32 v13, 2, v0
    v_mul_u32_u24 v13, 4160, v13
    v_lshl_add_u32 v12, v12, 4, v13
    v_add_u32 v12, s83, v12
    v_mov_b32 v14, 0
    v_mov_b32 v15, 0
    v_mov_b32 v16, 0
    v_mov_b32 v17, 0
    s_mov_b64 exec, 0xffff
    ds_write_b128 v12, v[14:17] offset:4096
    s_waitcnt lgkmcnt(0)
    s_mov_b64 exec, 1
    v_mov_b32 v18, s83
    ds_write_b16 v18, v19 offset:4096
    ds_write_b16 v18, v20 offset:15550
    s_branch Ltp_38
Ltp_37:
    s_waitcnt lgkmcnt(0)
    s_mov_b64 exec, 1
    v_mov_b32 v18, s83
    ds_write_b16 v18, v21 offset:11902
    ds_write_b16 v18, v21 offset:16060
Ltp_38:
    s_mov_b64 exec, s[74:75]
    s_waitcnt lgkmcnt(0)
    s_lshl_b32 s66, s61, 2
    s_add_u32 s66, s66, 152160
    v_mov_b32 v1, s66
    v_mov_b32 v2, 1
    ds_write_b32 v1, v2
    s_xor_b32 s66, s66, 4
    v_mov_b32 v1, s66
    s_mov_b32 s82, 1000000
Lps_39:
    ds_read_b32 v2, v1
    s_waitcnt lgkmcnt(0)
    v_readfirstlane_b32 s66, v2
    s_nop 2
    s_cmp_eq_u32 s66, 1
    s_cbranch_scc1 Lpd_40
    s_sub_u32 s82, s82, 1
    s_cmp_lg_u32 s82, 0
    s_cbranch_scc1 Lps_39
Lpd_40:
    v_mov_b32 v72, 0
    v_mov_b32 v73, 0
    v_mov_b32 v74, 0
    v_mov_b32 v75, 0
    v_cmp_gt_u32 vcc, 30, v152
    s_nop 2
    s_and_saveexec_b64 s[74:75], vcc
    ds_write_b128 v153, v[72:75]
    s_mov_b64 exec, s[74:75]
    s_waitcnt vmcnt(0)
    ds_write_b128 v153, v[156:159] offset:480
    ds_write_b128 v153, v[160:163] offset:2528
    s_lshr_b32 s62, s61, 1
    s_mul_i32 s76, s62, 17408
    s_add_u32 s76, s76, 0
    s_mul_i32 s77, s62, 4608
    s_add_u32 s77, s77, 152576
    s_and_b32 s78, s61, 1
    v_and_b32 v10, 15, v0
    v_lshrrev_b32 v11, 4, v0
    v_sub_u32 v12, 0, v10
    v_and_b32 v12, 3, v12
    v_mul_u32_u24 v8, 4160, v12
    v_lshlrev_b32 v13, 3, v11
    v_sub_u32 v13, v13, v10
    v_sub_u32 v13, v13, v12
    v_add_u32 v13, 240, v13
    v_lshl_add_u32 v8, v13, 1, v8
    s_lshl_b32 s62, s78, 8
    s_sub_u32 s63, s76, s62
    v_add_u32 v8, s63, v8
    v_lshlrev_b32 v9, 5, v10
    v_lshl_add_u32 v9, v11, 4, v9
    s_sub_u32 s63, s77, s62
    s_add_u32 s63, s63, 448
    v_add_u32 v9, s63, v9
    s_waitcnt lgkmcnt(0)
    s_lshl_b32 s66, s61, 2
    s_add_u32 s66, s66, 152104
    v_mov_b32 v1, s66
    v_mov_b32 v2, 1
    ds_write_b32 v1, v2
    s_xor_b32 s66, s66, 4
    v_mov_b32 v1, s66
    s_mov_b32 s82, 1000000
Lps_41:
    ds_read_b32 v2, v1
    s_waitcnt lgkmcnt(0)
    v_readfirstlane_b32 s66, v2
    s_nop 2
    s_cmp_eq_u32 s66, 1
    s_cbranch_scc1 Lpd_42
    s_sub_u32 s82, s82, 1
    s_cmp_lg_u32 s82, 0
    s_cbranch_scc1 Lps_41
Lpd_42:
    ds_read_b128 v[84:87], v9 offset:0
    ds_read_b64 v[52:53], v8 offset:3584
    ds_read_b64 v[54:55], v8 offset:3592
    ds_read_b128 v[88:91], v9 offset:512
    ds_read_b64 v[56:57], v8 offset:3072
    ds_read_b64 v[58:59], v8 offset:3080
    ds_read_b128 v[92:95], v9 offset:1024
    ds_read_b64 v[60:61], v8 offset:2560
    ds_read_b64 v[62:63], v8 offset:2568
    ds_read_b128 v[96:99], v9 offset:1536
    ds_read_b64 v[64:65], v8 offset:2048
    ds_read_b64 v[66:67], v8 offset:2056
    ds_read_b128 v[100:103], v9 offset:2048
    ds_read_b64 v[68:69], v8 offset:1536
    ds_read_b64 v[70:71], v8 offset:1544
    ds_read_b128 v[104:107], v9 offset:2560
    ds_read_b64 v[72:73], v8 offset:1024
    ds_read_b64 v[74:75], v8 offset:1032
    ds_read_b128 v[108:111], v9 offset:3072
    ds_read_b64 v[76:77], v8 offset:512
    ds_read_b64 v[78:79], v8 offset:520
    ds_read_b128 v[112:115], v9 offset:3584
    ds_read_b64 v[80:81], v8 offset:0
    ds_read_b64 v[82:83], v8 offset:8
    v_subrev_u32 v8, 64, v8
    v_subrev_u32 v9, 64, v9
    s_waitcnt lgkmcnt(0)
    v_mov_b32 v1, 152152
    s_mov_b32 s82, 2000000
Lwc_43:
    ds_read_b32 v2, v1
    s_waitcnt lgkmcnt(0)
    v_readfirstlane_b32 s66, v2
    s_nop 2
    s_cmp_ge_u32 s66, 4
    s_cbranch_scc1 Lwd_44
    s_sleep 1
    s_sub_u32 s82, s82, 1
    s_cmp_lg_u32 s82, 0
    s_cbranch_scc1 Lwc_43
Lwd_44:
    s_setprio 0
    s_waitcnt lgkmcnt(0)
    v_mfma_f32_16x16x32_bf16 v[20:23], v[52:55], v[84:87], 0
    ds_read_b128 v[148:151], v9 offset:0
    v_mfma_f32_16x16x32_bf16 v[24:27], v[52:55], v[88:91], 0
    ds_read_b64 v[116:117], v8 offset:3584
    v_mfma_f32_16x16x32_bf16 v[28:31], v[52:55], v[92:95], 0
    ds_read_b64 v[118:119], v8 offset:3592
    v_mfma_f32_16x16x32_bf16 v[32:35], v[52:55], v[96:99], 0
    ds_read_b128 v[152:155], v9 offset:512
    v_mfma_f32_16x16x32_bf16 v[36:39], v[52:55], v[100:103], 0
    ds_read_b64 v[120:121], v8 offset:3072
    v_mfma_f32_16x16x32_bf16 v[40:43], v[52:55], v[104:107], 0
    ds_read_b64 v[122:123], v8 offset:3080
    v_mfma_f32_16x16x32_bf16 v[44:47], v[52:55], v[108:111], 0
    ds_read_b128 v[156:159], v9 offset:1024
    v_mfma_f32_16x16x32_bf16 v[48:51], v[52:55], v[112:115], 0
    ds_read_b64 v[124:125], v8 offset:2560
    v_mfma_f32_16x16x32_bf16 v[24:27], v[56:59], v[84:87], v[24:27]
    ds_read_b64 v[126:127], v8 offset:2568
    v_mfma_f32_16x16x32_bf16 v[28:31], v[56:59], v[88:91], v[28:31]
    ds_read_b128 v[160:163], v9 offset:1536
    v_mfma_f32_16x16x32_bf16 v[32:35], v[56:59], v[92:95], v[32:35]
    ds_read_b64 v[128:129], v8 offset:2048
    v_mfma_f32_16x16x32_bf16 v[36:39], v[56:59], v[96:99], v[36:39]
    ds_read_b64 v[130:131], v8 offset:2056
    v_mfma_f32_16x16x32_bf16 v[40:43], v[56:59], v[100:103], v[40:43]
    ds_read_b128 v[164:167], v9 offset:2048
    v_mfma_f32_16x16x32_bf16 v[44:47], v[56:59], v[104:107], v[44:47]
    ds_read_b64 v[132:133], v8 offset:1536
    v_mfma_f32_16x16x32_bf16 v[48:51], v[56:59], v[108:111], v[48:51]
    ds_read_b64 v[134:135], v8 offset:1544
    v_mfma_f32_16x16x32_bf16 v[28:31], v[60:63], v[84:87], v[28:31]
    ds_read_b128 v[168:171], v9 offset:2560
    v_mfma_f32_16x16x32_bf16 v[32:35], v[60:63], v[88:91], v[32:35]
    ds_read_b64 v[136:137], v8 offset:1024
    v_mfma_f32_16x16x32_bf16 v[36:39], v[60:63], v[92:95], v[36:39]
    ds_read_b64 v[138:139], v8 offset:1032
    v_mfma_f32_16x16x32_bf16 v[40:43], v[60:63], v[96:99], v[40:43]
    ds_read_b128 v[172:175], v9 offset:3072
    v_mfma_f32_16x16x32_bf16 v[44:47], v[60:63], v[100:103], v[44:47]
    ds_read_b64 v[140:141], v8 offset:512
    v_mfma_f32_16x16x32_bf16 v[48:51], v[60:63], v[104:107], v[48:51]
    ds_read_b64 v[142:143], v8 offset:520
    v_mfma_f32_16x16x32_bf16 v[32:35], v[64:67], v[84:87], v[32:35]
    ds_read_b128 v[176:179], v9 offset:3584
    v_mfma_f32_16x16x32_bf16 v[36:39], v[64:67], v[88:91], v[36:39]
    ds_read_b64 v[144:145], v8 offset:0
    v_mfma_f32_16x16x32_bf16 v[40:43], v[64:67], v[92:95], v[40:43]
    ds_read_b64 v[146:147], v8 offset:8
    v_mfma_f32_16x16x32_bf16 v[44:47], v[64:67], v[96:99], v[44:47]
    v_subrev_u32 v8, 64, v8
    v_mfma_f32_16x16x32_bf16 v[48:51], v[64:67], v[100:103], v[48:51]
    v_subrev_u32 v9, 64, v9
    v_mfma_f32_16x16x32_bf16 v[36:39], v[68:71], v[84:87], v[36:39]
    v_mfma_f32_16x16x32_bf16 v[40:43], v[68:71], v[88:91], v[40:43]
    v_mfma_f32_16x16x32_bf16 v[44:47], v[68:71], v[92:95], v[44:47]
    v_mfma_f32_16x16x32_bf16 v[48:51], v[68:71], v[96:99], v[48:51]
    v_mfma_f32_16x16x32_bf16 v[40:43], v[72:75], v[84:87], v[40:43]
    v_mfma_f32_16x16x32_bf16 v[44:47], v[72:75], v[88:91], v[44:47]
    v_mfma_f32_16x16x32_bf16 v[48:51], v[72:75], v[92:95], v[48:51]
    v_mfma_f32_16x16x32_bf16 v[44:47], v[76:79], v[84:87], v[44:47]
    v_mfma_f32_16x16x32_bf16 v[48:51], v[76:79], v[88:91], v[48:51]
    v_mfma_f32_16x16x32_bf16 v[48:51], v[80:83], v[84:87], v[48:51]
    s_waitcnt lgkmcnt(0)
    v_mfma_f32_16x16x32_bf16 v[20:23], v[116:119], v[148:151], v[20:23]
    ds_read_b128 v[84:87], v9 offset:0
    v_mfma_f32_16x16x32_bf16 v[24:27], v[116:119], v[152:155], v[24:27]
    ds_read_b64 v[52:53], v8 offset:3584
    v_mfma_f32_16x16x32_bf16 v[28:31], v[116:119], v[156:159], v[28:31]
    ds_read_b64 v[54:55], v8 offset:3592
    v_mfma_f32_16x16x32_bf16 v[32:35], v[116:119], v[160:163], v[32:35]
    ds_read_b128 v[88:91], v9 offset:512
    v_mfma_f32_16x16x32_bf16 v[36:39], v[116:119], v[164:167], v[36:39]
    ds_read_b64 v[56:57], v8 offset:3072
    v_mfma_f32_16x16x32_bf16 v[40:43], v[116:119], v[168:171], v[40:43]
    ds_read_b64 v[58:59], v8 offset:3080
    v_mfma_f32_16x16x32_bf16 v[44:47], v[116:119], v[172:175], v[44:47]
    ds_read_b128 v[92:95], v9 offset:1024
    v_mfma_f32_16x16x32_bf16 v[48:51], v[116:119], v[176:179], v[48:51]
    ds_read_b64 v[60:61], v8 offset:2560
    v_mfma_f32_16x16x32_bf16 v[24:27], v[120:123], v[148:151], v[24:27]
    ds_read_b64 v[62:63], v8 offset:2568
    v_mfma_f32_16x16x32_bf16 v[28:31], v[120:123], v[152:155], v[28:31]
    ds_read_b128 v[96:99], v9 offset:1536
    v_mfma_f32_16x16x32_bf16 v[32:35], v[120:123], v[156:159], v[32:35]
    ds_read_b64 v[64:65], v8 offset:2048
    v_mfma_f32_16x16x32_bf16 v[36:39], v[120:123], v[160:163], v[36:39]
    ds_read_b64 v[66:67], v8 offset:2056
    v_mfma_f32_16x16x32_bf16 v[40:43], v[120:123], v[164:167], v[40:43]
    ds_read_b128 v[100:103], v9 offset:2048
    v_mfma_f32_16x16x32_bf16 v[44:47], v[120:123], v[168:171], v[44:47]
    ds_read_b64 v[68:69], v8 offset:1536
    v_mfma_f32_16x16x32_bf16 v[48:51], v[120:123], v[172:175], v[48:51]
    ds_read_b64 v[70:71], v8 offset:1544
    v_mfma_f32_16x16x32_bf16 v[28:31], v[124:127], v[148:151], v[28:31]
    ds_read_b128 v[104:107], v9 offset:2560
    v_mfma_f32_16x16x32_bf16 v[32:35], v[124:127], v[152:155], v[32:35]
    ds_read_b64 v[72:73], v8 offset:1024
    v_mfma_f32_16x16x32_bf16 v[36:39], v[124:127], v[156:159], v[36:39]
    ds_read_b64 v[74:75], v8 offset:1032
    v_mfma_f32_16x16x32_bf16 v[40:43], v[124:127], v[160:163], v[40:43]
    ds_read_b128 v[108:111], v9 offset:3072
    v_mfma_f32_16x16x32_bf16 v[44:47], v[124:127], v[164:167], v[44:47]
    ds_read_b64 v[76:77], v8 offset:512
    v_mfma_f32_16x16x32_bf16 v[48:51], v[124:127], v[168:171], v[48:51]
    ds_read_b64 v[78:79], v8 offset:520
    v_mfma_f32_16x16x32_bf16 v[32:35], v[128:131], v[148:151], v[32:35]
    ds_read_b128 v[112:115], v9 offset:3584
    v_mfma_f32_16x16x32_bf16 v[36:39], v[128:131], v[152:155], v[36:39]
    ds_read_b64 v[80:81], v8 offset:0
    v_mfma_f32_16x16x32_bf16 v[40:43], v[128:131], v[156:159], v[40:43]
    ds_read_b64 v[82:83], v8 offset:8
    v_mfma_f32_16x16x32_bf16 v[44:47], v[128:131], v[160:163], v[44:47]
    v_subrev_u32 v8, 64, v8
    v_mfma_f32_16x16x32_bf16 v[48:51], v[128:131], v[164:167], v[48:51]
    v_subrev_u32 v9, 64, v9
    v_mfma_f32_16x16x32_bf16 v[36:39], v[132:135], v[148:151], v[36:39]
    v_mfma_f32_16x16x32_bf16 v[40:43], v[132:135], v[152:155], v[40:43]
    v_mfma_f32_16x16x32_bf16 v[44:47], v[132:135], v[156:159], v[44:47]
    v_mfma_f32_16x16x32_bf16 v[48:51], v[132:135], v[160:163], v[48:51]
    v_mfma_f32_16x16x32_bf16 v[40:43], v[136:139], v[148:151], v[40:43]
    v_mfma_f32_16x16x32_bf16 v[44:47], v[136:139], v[152:155], v[44:47]
    v_mfma_f32_16x16x32_bf16 v[48:51], v[136:139], v[156:159], v[48:51]
    v_mfma_f32_16x16x32_bf16 v[44:47], v[140:143], v[148:151], v[44:47]
    v_mfma_f32_16x16x32_bf16 v[48:51], v[140:143], v[152:155], v[48:51]
    v_mfma_f32_16x16x32_bf16 v[48:51], v[144:147], v[148:151], v[48:51]
    s_waitcnt lgkmcnt(0)
    v_mfma_f32_16x16x32_bf16 v[20:23], v[52:55], v[84:87], v[20:23]
    ds_read_b128 v[148:151], v9 offset:0
    v_mfma_f32_16x16x32_bf16 v[24:27], v[52:55], v[88:91], v[24:27]
    ds_read_b64 v[116:117], v8 offset:3584
    v_mfma_f32_16x16x32_bf16 v[28:31], v[52:55], v[92:95], v[28:31]
    ds_read_b64 v[118:119], v8 offset:3592
    v_mfma_f32_16x16x32_bf16 v[32:35], v[52:55], v[96:99], v[32:35]
    ds_read_b128 v[152:155], v9 offset:512
    v_mfma_f32_16x16x32_bf16 v[36:39], v[52:55], v[100:103], v[36:39]
    ds_read_b64 v[120:121], v8 offset:3072
    v_mfma_f32_16x16x32_bf16 v[40:43], v[52:55], v[104:107], v[40:43]
    ds_read_b64 v[122:123], v8 offset:3080
    v_mfma_f32_16x16x32_bf16 v[44:47], v[52:55], v[108:111], v[44:47]
    ds_read_b128 v[156:159], v9 offset:1024
    v_mfma_f32_16x16x32_bf16 v[48:51], v[52:55], v[112:115], v[48:51]
    ds_read_b64 v[124:125], v8 offset:2560
    v_mfma_f32_16x16x32_bf16 v[24:27], v[56:59], v[84:87], v[24:27]
    ds_read_b64 v[126:127], v8 offset:2568
    v_mfma_f32_16x16x32_bf16 v[28:31], v[56:59], v[88:91], v[28:31]
    ds_read_b128 v[160:163], v9 offset:1536
    v_mfma_f32_16x16x32_bf16 v[32:35], v[56:59], v[92:95], v[32:35]
    ds_read_b64 v[128:129], v8 offset:2048
    v_mfma_f32_16x16x32_bf16 v[36:39], v[56:59], v[96:99], v[36:39]
    ds_read_b64 v[130:131], v8 offset:2056
    v_mfma_f32_16x16x32_bf16 v[40:43], v[56:59], v[100:103], v[40:43]
    ds_read_b128 v[164:167], v9 offset:2048
    v_mfma_f32_16x16x32_bf16 v[44:47], v[56:59], v[104:107], v[44:47]
    ds_read_b64 v[132:133], v8 offset:1536
    v_mfma_f32_16x16x32_bf16 v[48:51], v[56:59], v[108:111], v[48:51]
    ds_read_b64 v[134:135], v8 offset:1544
    v_mfma_f32_16x16x32_bf16 v[28:31], v[60:63], v[84:87], v[28:31]
    ds_read_b128 v[168:171], v9 offset:2560
    v_mfma_f32_16x16x32_bf16 v[32:35], v[60:63], v[88:91], v[32:35]
    ds_read_b64 v[136:137], v8 offset:1024
    v_mfma_f32_16x16x32_bf16 v[36:39], v[60:63], v[92:95], v[36:39]
    ds_read_b64 v[138:139], v8 offset:1032
    v_mfma_f32_16x16x32_bf16 v[40:43], v[60:63], v[96:99], v[40:43]
    ds_read_b128 v[172:175], v9 offset:3072
    v_mfma_f32_16x16x32_bf16 v[44:47], v[60:63], v[100:103], v[44:47]
    ds_read_b64 v[140:141], v8 offset:512
    v_mfma_f32_16x16x32_bf16 v[48:51], v[60:63], v[104:107], v[48:51]
    ds_read_b64 v[142:143], v8 offset:520
    v_mfma_f32_16x16x32_bf16 v[32:35], v[64:67], v[84:87], v[32:35]
    ds_read_b128 v[176:179], v9 offset:3584
    v_mfma_f32_16x16x32_bf16 v[36:39], v[64:67], v[88:91], v[36:39]
    ds_read_b64 v[144:145], v8 offset:0
    v_mfma_f32_16x16x32_bf16 v[40:43], v[64:67], v[92:95], v[40:43]
    ds_read_b64 v[146:147], v8 offset:8
    v_mfma_f32_16x16x32_bf16 v[44:47], v[64:67], v[96:99], v[44:47]
    v_subrev_u32 v8, 64, v8
    v_mfma_f32_16x16x32_bf16 v[48:51], v[64:67], v[100:103], v[48:51]
    v_subrev_u32 v9, 64, v9
    v_mfma_f32_16x16x32_bf16 v[36:39], v[68:71], v[84:87], v[36:39]
    v_mfma_f32_16x16x32_bf16 v[40:43], v[68:71], v[88:91], v[40:43]
    v_mfma_f32_16x16x32_bf16 v[44:47], v[68:71], v[92:95], v[44:47]
    v_mfma_f32_16x16x32_bf16 v[48:51], v[68:71], v[96:99], v[48:51]
    v_mfma_f32_16x16x32_bf16 v[40:43], v[72:75], v[84:87], v[40:43]
    v_mfma_f32_16x16x32_bf16 v[44:47], v[72:75], v[88:91], v[44:47]
    v_mfma_f32_16x16x32_bf16 v[48:51], v[72:75], v[92:95], v[48:51]
    v_mfma_f32_16x16x32_bf16 v[44:47], v[76:79], v[84:87], v[44:47]
    v_mfma_f32_16x16x32_bf16 v[48:51], v[76:79], v[88:91], v[48:51]
    v_mfma_f32_16x16x32_bf16 v[48:51], v[80:83], v[84:87], v[48:51]
    s_waitcnt lgkmcnt(0)
    v_mfma_f32_16x16x32_bf16 v[20:23], v[116:119], v[148:151], v[20:23]
    v_mfma_f32_16x16x32_bf16 v[24:27], v[116:119], v[152:155], v[24:27]
    v_mfma_f32_16x16x32_bf16 v[28:31], v[116:119], v[156:159], v[28:31]
    v_mfma_f32_16x16x32_bf16 v[32:35], v[116:119], v[160:163], v[32:35]
    v_mfma_f32_16x16x32_bf16 v[36:39], v[116:119], v[164:167], v[36:39]
    v_mfma_f32_16x16x32_bf16 v[40:43], v[116:119], v[168:171], v[40:43]
    v_mfma_f32_16x16x32_bf16 v[44:47], v[116:119], v[172:175], v[44:47]
    v_mfma_f32_16x16x32_bf16 v[48:51], v[116:119], v[176:179], v[48:51]
    v_mfma_f32_16x16x32_bf16 v[24:27], v[120:123], v[148:151], v[24:27]
    v_mfma_f32_16x16x32_bf16 v[28:31], v[120:123], v[152:155], v[28:31]
    v_mfma_f32_16x16x32_bf16 v[32:35], v[120:123], v[156:159], v[32:35]
    v_mfma_f32_16x16x32_bf16 v[36:39], v[120:123], v[160:163], v[36:39]
    v_mfma_f32_16x16x32_bf16 v[40:43], v[120:123], v[164:167], v[40:43]
    v_mfma_f32_16x16x32_bf16 v[44:47], v[120:123], v[168:171], v[44:47]
    v_mfma_f32_16x16x32_bf16 v[48:51], v[120:123], v[172:175], v[48:51]
    v_mfma_f32_16x16x32_bf16 v[28:31], v[124:127], v[148:151], v[28:31]
    v_mfma_f32_16x16x32_bf16 v[32:35], v[124:127], v[152:155], v[32:35]
    v_mfma_f32_16x16x32_bf16 v[36:39], v[124:127], v[156:159], v[36:39]
    v_mfma_f32_16x16x32_bf16 v[40:43], v[124:127], v[160:163], v[40:43]
    v_mfma_f32_16x16x32_bf16 v[44:47], v[124:127], v[164:167], v[44:47]
    v_mfma_f32_16x16x32_bf16 v[48:51], v[124:127], v[168:171], v[48:51]
    v_mfma_f32_16x16x32_bf16 v[32:35], v[128:131], v[148:151], v[32:35]
    v_mfma_f32_16x16x32_bf16 v[36:39], v[128:131], v[152:155], v[36:39]
    v_mfma_f32_16x16x32_bf16 v[40:43], v[128:131], v[156:159], v[40:43]
    v_mfma_f32_16x16x32_bf16 v[44:47], v[128:131], v[160:163], v[44:47]
    v_mfma_f32_16x16x32_bf16 v[48:51], v[128:131], v[164:167], v[48:51]
    v_mfma_f32_16x16x32_bf16 v[36:39], v[132:135], v[148:151], v[36:39]
    v_mfma_f32_16x16x32_bf16 v[40:43], v[132:135], v[152:155], v[40:43]
    v_mfma_f32_16x16x32_bf16 v[44:47], v[132:135], v[156:159], v[44:47]
    v_mfma_f32_16x16x32_bf16 v[48:51], v[132:135], v[160:163], v[48:51]
    v_mfma_f32_16x16x32_bf16 v[40:43], v[136:139], v[148:151], v[40:43]
    v_mfma_f32_16x16x32_bf16 v[44:47], v[136:139], v[152:155], v[44:47]
    v_mfma_f32_16x16x32_bf16 v[48:51], v[136:139], v[156:159], v[48:51]
    v_mfma_f32_16x16x32_bf16 v[44:47], v[140:143], v[148:151], v[44:47]
    v_mfma_f32_16x16x32_bf16 v[48:51], v[140:143], v[152:155], v[48:51]
    v_mfma_f32_16x16x32_bf16 v[48:51], v[144:147], v[148:151], v[48:51]
    s_lshr_b32 s62, s61, 1
    s_lshl_b32 s79, s2, 1
    s_add_u32 s79, s79, s62
    s_lshl_b32 s79, s79, 12
    s_add_u32 s79, s79, 10485760
    s_lshl_b32 s62, s61, 12
    s_add_u32 s62, s62, 133120
    v_lshl_add_u32 v10, v0, 4, s62
    s_xor_b32 s63, s61, 1
    s_lshl_b32 s64, s63, 12
    s_add_u32 s64, s64, 133120
    v_lshl_add_u32 v11, v0, 4, s64
    s_and_b32 s65, s61, 1
    s_cmp_eq_u32 s65, 1
    s_cbranch_scc1 Lxh_45
    ds_write_b128 v10, v[36:39] offset:0
    ds_write_b128 v10, v[40:43] offset:1024
    ds_write_b128 v10, v[44:47] offset:2048
    ds_write_b128 v10, v[48:51] offset:3072
    s_branch Lxj_46
Lxh_45:
    ds_write_b128 v10, v[20:23] offset:0
    ds_write_b128 v10, v[24:27] offset:1024
    ds_write_b128 v10, v[28:31] offset:2048
    ds_write_b128 v10, v[32:35] offset:3072
    v_mov_b32 v20, v36
    v_mov_b32 v21, v37
    v_mov_b32 v22, v38
    v_mov_b32 v23, v39
    v_mov_b32 v24, v40
    v_mov_b32 v25, v41
    v_mov_b32 v26, v42
    v_mov_b32 v27, v43
    v_mov_b32 v28, v44
    v_mov_b32 v29, v45
    v_mov_b32 v30, v46
    v_mov_b32 v31, v47
    v_mov_b32 v32, v48
    v_mov_b32 v33, v49
    v_mov_b32 v34, v50
    v_mov_b32 v35, v51
Lxj_46:
    s_waitcnt lgkmcnt(0)
    s_lshl_b32 s66, s61, 2
    s_add_u32 s66, s66, 152080
    v_mov_b32 v12, s66
    v_mov_b32 v13, 1
    ds_write_b32 v12, v13
    s_lshl_b32 s66, s63, 2
    s_add_u32 s66, s66, 152080
    v_mov_b32 v12, s66
    s_mov_b32 s82, 1000000
Lxs_47:
    ds_read_b32 v13, v12
    s_waitcnt lgkmcnt(0)
    v_readfirstlane_b32 s66, v13
    s_nop 2
    s_cmp_eq_u32 s66, 1
    s_cbranch_scc1 Lxd_48
    s_sub_u32 s82, s82, 1
    s_cmp_lg_u32 s82, 0
    s_cbranch_scc1 Lxs_47
Lxd_48:
    ds_read_b128 v[116:119], v11 offset:0
    ds_read_b128 v[120:123], v11 offset:1024
    ds_read_b128 v[124:127], v11 offset:2048
    ds_read_b128 v[128:131], v11 offset:3072
    v_and_b32 v10, 15, v0
    v_lshrrev_b32 v11, 4, v0
    v_lshlrev_b32 v12, 5, v10
    v_lshl_add_u32 v12, v11, 3, v12
    s_lshl_b32 s65, s65, 11
    s_add_u32 s66, s77, s65
    v_add_u32 v18, s66, v12
    s_add_u32 s79, s79, s65
    ds_read_b64 v[52:53], v18 offset:480
    ds_read_b64 v[54:55], v18 offset:992
    ds_read_b64 v[56:57], v18 offset:1504
    ds_read_b64 v[58:59], v18 offset:2016
    s_waitcnt lgkmcnt(0)
    s_lshl_b32 s66, s61, 2
    s_add_u32 s66, s66, 152256
    v_mov_b32 v10, s66
    v_mov_b32 v11, 1
    ds_write_b32 v10, v11
    v_add_f32 v20, v20, v116
    v_add_f32 v21, v21, v117
    v_add_f32 v22, v22, v118
    v_add_f32 v23, v23, v119
    v_add_f32 v24, v24, v120
    v_add_f32 v25, v25, v121
    v_add_f32 v26, v26, v122
    v_add_f32 v27, v27, v123
    v_add_f32 v28, v28, v124
    v_add_f32 v29, v29, v125
    v_add_f32 v30, v30, v126
    v_add_f32 v31, v31, v127
    v_add_f32 v32, v32, v128
    v_add_f32 v33, v33, v129
    v_add_f32 v34, v34, v130
    v_add_f32 v35, v35, v131
    v_lshlrev_b32 v84, 16, v52
    v_and_b32 v85, 0xffff0000, v52
    v_lshlrev_b32 v86, 16, v53
    v_and_b32 v87, 0xffff0000, v53
    v_mul_f32 v84, s35, v84
    v_mul_f32 v85, s35, v85
    v_mul_f32 v86, s35, v86
    v_mul_f32 v87, s35, v87
    v_cvt_pk_bf16_f32 v84, v84, v85
    v_cvt_pk_bf16_f32 v86, v86, v87
    v_cvt_pk_bf16_f32 v20, v20, v21
    v_cvt_pk_bf16_f32 v22, v22, v23
    v_lshlrev_b32 v85, 16, v84
    v_and_b32 v84, 0xffff0000, v84
    v_lshlrev_b32 v87, 16, v86
    v_and_b32 v86, 0xffff0000, v86
    v_lshlrev_b32 v21, 16, v20
    v_and_b32 v20, 0xffff0000, v20
    v_lshlrev_b32 v23, 16, v22
    v_and_b32 v22, 0xffff0000, v22
    v_add_f32 v85, v85, v21
    v_add_f32 v84, v84, v20
    v_add_f32 v87, v87, v23
    v_add_f32 v86, v86, v22
    v_cvt_pk_bf16_f32 v20, v85, v84
    v_cvt_pk_bf16_f32 v21, v87, v86
    buffer_store_dwordx2 v[20:21], v12, s[44:47], s79 offen offset:0 sc1
    v_lshlrev_b32 v88, 16, v54
    v_and_b32 v89, 0xffff0000, v54
    v_lshlrev_b32 v90, 16, v55
    v_and_b32 v91, 0xffff0000, v55
    v_mul_f32 v88, s35, v88
    v_mul_f32 v89, s35, v89
    v_mul_f32 v90, s35, v90
    v_mul_f32 v91, s35, v91
    v_cvt_pk_bf16_f32 v88, v88, v89
    v_cvt_pk_bf16_f32 v90, v90, v91
    v_cvt_pk_bf16_f32 v24, v24, v25
    v_cvt_pk_bf16_f32 v26, v26, v27
    v_lshlrev_b32 v89, 16, v88
    v_and_b32 v88, 0xffff0000, v88
    v_lshlrev_b32 v91, 16, v90
    v_and_b32 v90, 0xffff0000, v90
    v_lshlrev_b32 v25, 16, v24
    v_and_b32 v24, 0xffff0000, v24
    v_lshlrev_b32 v27, 16, v26
    v_and_b32 v26, 0xffff0000, v26
    v_add_f32 v89, v89, v25
    v_add_f32 v88, v88, v24
    v_add_f32 v91, v91, v27
    v_add_f32 v90, v90, v26
    v_cvt_pk_bf16_f32 v24, v89, v88
    v_cvt_pk_bf16_f32 v25, v91, v90
    buffer_store_dwordx2 v[24:25], v12, s[44:47], s79 offen offset:512 sc1
    v_lshlrev_b32 v92, 16, v56
    v_and_b32 v93, 0xffff0000, v56
    v_lshlrev_b32 v94, 16, v57
    v_and_b32 v95, 0xffff0000, v57
    v_mul_f32 v92, s35, v92
    v_mul_f32 v93, s35, v93
    v_mul_f32 v94, s35, v94
    v_mul_f32 v95, s35, v95
    v_cvt_pk_bf16_f32 v92, v92, v93
    v_cvt_pk_bf16_f32 v94, v94, v95
    v_cvt_pk_bf16_f32 v28, v28, v29
    v_cvt_pk_bf16_f32 v30, v30, v31
    v_lshlrev_b32 v93, 16, v92
    v_and_b32 v92, 0xffff0000, v92
    v_lshlrev_b32 v95, 16, v94
    v_and_b32 v94, 0xffff0000, v94
    v_lshlrev_b32 v29, 16, v28
    v_and_b32 v28, 0xffff0000, v28
    v_lshlrev_b32 v31, 16, v30
    v_and_b32 v30, 0xffff0000, v30
    v_add_f32 v93, v93, v29
    v_add_f32 v92, v92, v28
    v_add_f32 v95, v95, v31
    v_add_f32 v94, v94, v30
    v_cvt_pk_bf16_f32 v28, v93, v92
    v_cvt_pk_bf16_f32 v29, v95, v94
    buffer_store_dwordx2 v[28:29], v12, s[44:47], s79 offen offset:1024 sc1
    v_lshlrev_b32 v96, 16, v58
    v_and_b32 v97, 0xffff0000, v58
    v_lshlrev_b32 v98, 16, v59
    v_and_b32 v99, 0xffff0000, v59
    v_mul_f32 v96, s35, v96
    v_mul_f32 v97, s35, v97
    v_mul_f32 v98, s35, v98
    v_mul_f32 v99, s35, v99
    v_cvt_pk_bf16_f32 v96, v96, v97
    v_cvt_pk_bf16_f32 v98, v98, v99
    v_cvt_pk_bf16_f32 v32, v32, v33
    v_cvt_pk_bf16_f32 v34, v34, v35
    v_lshlrev_b32 v97, 16, v96
    v_and_b32 v96, 0xffff0000, v96
    v_lshlrev_b32 v99, 16, v98
    v_and_b32 v98, 0xffff0000, v98
    v_lshlrev_b32 v33, 16, v32
    v_and_b32 v32, 0xffff0000, v32
    v_lshlrev_b32 v35, 16, v34
    v_and_b32 v34, 0xffff0000, v34
    v_add_f32 v97, v97, v33
    v_add_f32 v96, v96, v32
    v_add_f32 v99, v99, v35
    v_add_f32 v98, v98, v34
    v_cvt_pk_bf16_f32 v32, v97, v96
    v_cvt_pk_bf16_f32 v33, v99, v98
    buffer_store_dwordx2 v[32:33], v12, s[44:47], s79 offen offset:1536 sc1
    s_waitcnt vmcnt(0)
    s_lshl_b32 s62, s2, 6
    s_add_u32 s62, s62, 65536
    v_mov_b32 v20, 152072
    v_mov_b32 v21, 1
    s_mov_b64 s[74:75], exec
    s_mov_b64 exec, 1
    ds_add_rtn_u32 v21, v20, v21
    s_waitcnt lgkmcnt(0)
    v_readfirstlane_b32 s68, v21
    s_nop 2
    s_cmp_lg_u32 s68, 3
    s_cbranch_scc1 Lsig_49
    v_mov_b32 v20, 0
    v_mov_b32 v21, s34
    buffer_store_dword v21, v20, s[44:47], s62 offen sc1
Lsig_49:
    s_mov_b64 exec, s[74:75]
    s_setprio 0
    s_and_b32 s62, s2, 7
    s_lshr_b32 s63, s2, 3
    s_lshl_b32 s76, s62, 2
    s_and_b32 s64, s63, 3
    s_add_u32 s76, s76, s64
    s_lshr_b32 s77, s63, 2
    v_lshlrev_b32 v9, 4, v0
    s_mul_i32 s83, s76, 176128
    s_add_u32 s83, s83, 1048576
    s_lshl_b32 s62, s76, 9
    s_add_u32 s78, s62, 32768
    v_lshrrev_b32 v2, 4, v0
    v_lshrrev_b32 v3, 2, v0
    v_and_b32 v3, 3, v3
    v_and_b32 v1, 3, v0
    v_lshlrev_b32 v2, 5, v2
    v_lshl_add_u32 v2, v1, 3, v2
    v_lshl_add_u32 v3, v3, 12, v2
    s_lshl_b32 s62, s76, 16
    s_lshl_b32 s63, s77, 7
    s_add_u32 s62, s62, s63
    s_lshr_b32 s64, s3, 1
    s_lshl_b32 s64, s64, 14
    s_add_u32 s62, s62, s64
    s_and_b32 s64, s3, 1
    s_lshl_b32 s64, s64, 11
    s_add_u32 s62, s62, s64
    v_add_u32 v3, s62, v3
    buffer_load_dwordx2 v[10:11], v3, s[36:39], 0 offen
    buffer_load_dwordx2 v[12:13], v3, s[36:39], 0 offen offset:1024
    v_add_u32 v2, s63, v2
    global_load_dwordx2 v[14:15], v2, s[26:27]
    v_lshlrev_b32 v1, 6, v0
    s_lshl_b32 s62, s77, 5
    s_lshl_b32 s64, s61, 3
    s_add_u32 s62, s62, s64
    s_lshl_b32 s62, s62, 6
    s_add_u32 s78, s62, 65536
    v_mov_b32 v1, 152180
    s_mov_b32 s82, 2000000
Lwc_50:
    ds_read_b32 v2, v1
    s_waitcnt lgkmcnt(0)
    v_readfirstlane_b32 s66, v2
    s_nop 2
    s_cmp_ge_u32 s66, 4
    s_cbranch_scc1 Lwd_51
    s_sleep 1
    s_sub_u32 s82, s82, 1
    s_cmp_lg_u32 s82, 0
    s_cbranch_scc1 Lwc_50
Lwd_51:
    v_lshlrev_b32 v1, 6, v0
    s_mov_b64 s[74:75], exec
    s_mov_b32 exec_lo, 0xff
    s_mov_b32 exec_hi, 0
    s_mov_b32 s82, 200000
Lpoll_52:
    buffer_load_dword v2, v1, s[44:47], s78 offen sc1
    s_waitcnt vmcnt(0)
    v_cmp_ne_u32 vcc, s34, v2
    s_nop 4
    s_cbranch_vccz Lpolld_53
    s_sub_u32 s82, s82, 1
    s_cmp_eq_u32 s82, 0
    s_cbranch_scc1 Lpolld_53
    s_sleep 2
    s_branch Lpoll_52
Lpolld_53:
    s_mov_b64 exec, s[74:75]
    v_and_b32 v1, 15, v0
    v_lshlrev_b32 v1, 12, v1
    v_lshrrev_b32 v2, 4, v0
    v_lshl_add_u32 v1, v2, 3, v1
    s_lshl_b32 s62, s77, 2
    s_add_u32 s62, s62, s61
    s_lshl_b32 s62, s62, 16
    s_lshl_b32 s64, s76, 7
    s_add_u32 s62, s62, s64
    s_add_u32 s62, s62, 10485760
    buffer_load_dwordx2 v[16:17], v1, s[44:47], s62 offen offset:0 sc1
    buffer_load_dwordx2 v[18:19], v1, s[44:47], s62 offen offset:32 sc1
    buffer_load_dwordx2 v[20:21], v1, s[44:47], s62 offen offset:64 sc1
    buffer_load_dwordx2 v[22:23], v1, s[44:47], s62 offen offset:96 sc1
    s_waitcnt vmcnt(0)
    v_lshlrev_b32 v64, 16, v16
    v_and_b32 v65, 0xffff0000, v16
    v_lshlrev_b32 v66, 16, v17
    v_and_b32 v67, 0xffff0000, v17
    v_lshlrev_b32 v68, 16, v18
    v_and_b32 v69, 0xffff0000, v18
    v_lshlrev_b32 v70, 16, v19
    v_and_b32 v71, 0xffff0000, v19
    v_lshlrev_b32 v72, 16, v20
    v_and_b32 v73, 0xffff0000, v20
    v_lshlrev_b32 v74, 16, v21
    v_and_b32 v75, 0xffff0000, v21
    v_lshlrev_b32 v76, 16, v22
    v_and_b32 v77, 0xffff0000, v22
    v_lshlrev_b32 v78, 16, v23
    v_and_b32 v79, 0xffff0000, v23
    s_xor_b32 s66, s61, 1
    s_lshl_b32 s66, s66, 2
    s_add_u32 s66, s66, 152256
    v_mov_b32 v1, s66
    s_mov_b32 s82, 2000000
Lp5_54:
    ds_read_b32 v2, v1
    s_waitcnt lgkmcnt(0)
    v_readfirstlane_b32 s66, v2
    s_nop 2
    s_cmp_eq_u32 s66, 1
    s_cbranch_scc1 Lp5d_55
    s_sub_u32 s82, s82, 1
    s_cmp_lg_u32 s82, 0
    s_cbranch_scc1 Lp5_54
Lp5d_55:
    s_lshl_b32 s62, s61, 12
    s_add_u32 s62, s62, 133120
    v_lshl_add_u32 v1, v0, 2, s62
    ds_write_b32 v1, v64 offset:0
    ds_write_b32 v1, v65 offset:256
    ds_write_b32 v1, v66 offset:512
    ds_write_b32 v1, v67 offset:768
    ds_write_b32 v1, v68 offset:1024
    ds_write_b32 v1, v69 offset:1280
    ds_write_b32 v1, v70 offset:1536
    ds_write_b32 v1, v71 offset:1792
    ds_write_b32 v1, v72 offset:2048
    ds_write_b32 v1, v73 offset:2304
    ds_write_b32 v1, v74 offset:2560
    ds_write_b32 v1, v75 offset:2816
    ds_write_b32 v1, v76 offset:3072
    ds_write_b32 v1, v77 offset:3328
    ds_write_b32 v1, v78 offset:3584
    ds_write_b32 v1, v79 offset:3840
    s_waitcnt lgkmcnt(0)
L_tail:
L_f0:
    s_barrier
    v_lshrrev_b32 v2, 4, v0
    v_and_b32 v1, 15, v0
    v_lshlrev_b32 v1, 4, v1
    v_lshl_add_u32 v4, v2, 10, v1
    s_lshr_b32 s62, s3, 1
    s_and_b32 s63, s3, 1
    s_lshl_b32 s63, s63, 1
    s_lshl_b32 s64, s62, 12
    s_lshl_b32 s65, s63, 8
    s_add_u32 s64, s64, s65
    s_add_u32 s64, s64, 34816
    v_add_u32 v4, s64, v4
    v_add_u32 v5, 32768, v4
    v_lshl_add_u32 v6, v2, 12, v1
    s_lshl_b32 s64, s62, 10
    s_add_u32 s64, s64, s65
    s_add_u32 s64, s64, 133120
    v_add_u32 v6, s64, v6
    ds_read_b128 v[64:67], v4 offset:0
    ds_read_b128 v[68:71], v4 offset:16384
    ds_read_b128 v[72:75], v5 offset:0
    ds_read_b128 v[76:79], v5 offset:16384
    ds_read_b128 v[80:83], v6 offset:0
    ds_read_b128 v[96:99], v4 offset:256
    ds_read_b128 v[100:103], v4 offset:16640
    ds_read_b128 v[104:107], v5 offset:256
    ds_read_b128 v[108:111], v5 offset:16640
    ds_read_b128 v[112:115], v6 offset:256
    v_lshlrev_b32 v32, 16, v14
    v_and_b32 v33, 0xffff0000, v14
    v_lshlrev_b32 v34, 16, v15
    v_and_b32 v35, 0xffff0000, v15
    s_waitcnt lgkmcnt(5)
    v_pk_add_f32 v[64:65], v[64:65], v[68:69]
    v_pk_add_f32 v[66:67], v[66:67], v[70:71]
    v_pk_add_f32 v[72:73], v[72:73], v[76:77]
    v_pk_add_f32 v[74:75], v[74:75], v[78:79]
    v_pk_add_f32 v[64:65], v[64:65], v[72:73]
    v_pk_add_f32 v[66:67], v[66:67], v[74:75]
    v_lshlrev_b32 v24, 16, v10
    v_and_b32 v25, 0xffff0000, v10
    v_lshlrev_b32 v26, 16, v11
    v_and_b32 v27, 0xffff0000, v11
    v_pk_add_f32 v[24:25], v[24:25], v[80:81]
    v_pk_add_f32 v[26:27], v[26:27], v[82:83]
    v_cvt_pk_bf16_f32 v24, v24, v25
    v_cvt_pk_bf16_f32 v26, v26, v27
    v_cvt_pk_bf16_f32 v64, v64, v65
    v_cvt_pk_bf16_f32 v66, v66, v67
    v_and_b32 v25, 0xffff0000, v24
    v_lshlrev_b32 v24, 16, v24
    v_and_b32 v27, 0xffff0000, v26
    v_lshlrev_b32 v26, 16, v26
    v_and_b32 v65, 0xffff0000, v64
    v_lshlrev_b32 v64, 16, v64
    v_and_b32 v67, 0xffff0000, v66
    v_lshlrev_b32 v66, 16, v66
    v_pk_add_f32 v[64:65], v[64:65], v[32:33]
    v_pk_add_f32 v[66:67], v[66:67], v[34:35]
    v_cvt_pk_bf16_f32 v64, v64, v65
    v_cvt_pk_bf16_f32 v66, v66, v67
    v_and_b32 v65, 0xffff0000, v64
    v_lshlrev_b32 v64, 16, v64
    v_and_b32 v67, 0xffff0000, v66
    v_lshlrev_b32 v66, 16, v66
    v_pk_add_f32 v[24:25], v[24:25], v[64:65]
    v_pk_add_f32 v[26:27], v[26:27], v[66:67]
    v_cvt_pk_bf16_f32 v28, v24, v25
    v_cvt_pk_bf16_f32 v29, v26, v27
    buffer_store_dwordx2 v[28:29], v3, s[48:51], 0 offen offset:0
    s_waitcnt lgkmcnt(0)
    v_pk_add_f32 v[96:97], v[96:97], v[100:101]
    v_pk_add_f32 v[98:99], v[98:99], v[102:103]
    v_pk_add_f32 v[104:105], v[104:105], v[108:109]
    v_pk_add_f32 v[106:107], v[106:107], v[110:111]
    v_pk_add_f32 v[96:97], v[96:97], v[104:105]
    v_pk_add_f32 v[98:99], v[98:99], v[106:107]
    v_lshlrev_b32 v24, 16, v12
    v_and_b32 v25, 0xffff0000, v12
    v_lshlrev_b32 v26, 16, v13
    v_and_b32 v27, 0xffff0000, v13
    v_pk_add_f32 v[24:25], v[24:25], v[112:113]
    v_pk_add_f32 v[26:27], v[26:27], v[114:115]
    v_cvt_pk_bf16_f32 v24, v24, v25
    v_cvt_pk_bf16_f32 v26, v26, v27
    v_cvt_pk_bf16_f32 v96, v96, v97
    v_cvt_pk_bf16_f32 v98, v98, v99
    v_and_b32 v25, 0xffff0000, v24
    v_lshlrev_b32 v24, 16, v24
    v_and_b32 v27, 0xffff0000, v26
    v_lshlrev_b32 v26, 16, v26
    v_and_b32 v97, 0xffff0000, v96
    v_lshlrev_b32 v96, 16, v96
    v_and_b32 v99, 0xffff0000, v98
    v_lshlrev_b32 v98, 16, v98
    v_pk_add_f32 v[96:97], v[96:97], v[32:33]
    v_pk_add_f32 v[98:99], v[98:99], v[34:35]
    v_cvt_pk_bf16_f32 v96, v96, v97
    v_cvt_pk_bf16_f32 v98, v98, v99
    v_and_b32 v97, 0xffff0000, v96
    v_lshlrev_b32 v96, 16, v96
    v_and_b32 v99, 0xffff0000, v98
    v_lshlrev_b32 v98, 16, v98
    v_pk_add_f32 v[24:25], v[24:25], v[96:97]
    v_pk_add_f32 v[26:27], v[26:27], v[98:99]
    v_cvt_pk_bf16_f32 v30, v24, v25
    v_cvt_pk_bf16_f32 v31, v26, v27
    buffer_store_dwordx2 v[30:31], v3, s[48:51], 0 offen offset:1024
    s_waitcnt vmcnt(0)
L_end:
    s_endpgm
L_kend:

.section .rodata,"a"
.p2align 6
.amdhsa_kernel parallel_sum__ssm_conv_s4d__mixer_channel_mlp__prompt_kernel
  .amdhsa_next_free_vgpr 256
  .amdhsa_next_free_sgpr 102
  .amdhsa_accum_offset 256
  .amdhsa_group_segment_fixed_size 0
  .amdhsa_kernarg_size 120
  .amdhsa_user_sgpr_count 2
  .amdhsa_user_sgpr_kernarg_segment_ptr 1
  .amdhsa_system_sgpr_workgroup_id_x 1
  .amdhsa_float_denorm_mode_32 3
  .amdhsa_float_denorm_mode_16_64 3
.end_amdhsa_kernel
```
